```python
import torch

def _softmax(x, axis=-1):
    return torch.softmax(x, dim=axis)
def _gelu(x):
    return torch.nn.functional.gelu(x, approximate="tanh")
def _silu(x):
    return torch.nn.functional.silu(x)
def _sigmoid(x):
    return torch.sigmoid(x)
def _layernorm(x, axis=-1, eps=1e-5):
    m = x.mean(dim=axis, keepdim=True)
    v = x.var(dim=axis, keepdim=True, unbiased=False)
    return (x - m) / torch.sqrt(v + eps)
def _scatter_add(tgt, idx, src, axis=0):
    return tgt.clone().index_add_(axis, idx, src)
def _segment_sum(src, seg, n):
    out = torch.zeros((n,) + src.shape[1:], dtype=src.dtype)
    return out.index_add_(0, seg, src)
def _pad(x, pw):
    flat = tuple(v for pair in reversed(pw) for v in pair)
    return torch.nn.functional.pad(x, flat)

kernel_name = 'sequential_preLN__compressed_kv_cla__glu_gated_geglu__decode'

def setup_inputs():

    _w = (lambda a: (lambda t: t.to(torch.bfloat16) if t.is_floating_point() else t)(torch.as_tensor(a)))
    def _A_setup():
        B, H, Sq, Sk, D, M = 1, 32, 1, 8192, 128, 640
        Dc = 4 * D
        return {
            "x": _w((lambda *s: torch.randn(*s, dtype=torch.bfloat16) * 0.05)(B, Sq, M)),
            "c_kv": _w((lambda *s: torch.randn(*s, dtype=torch.bfloat16) * 0.8)(B, Sk, Dc)),
            "w_q": _w((lambda *s: torch.randn(*s, dtype=torch.bfloat16) * 1.6)(M, H, D) * (M ** -0.5)),
            "w_uk": _w((lambda *s: torch.randn(*s, dtype=torch.bfloat16) * 1.6)(Dc, H, D) * (Dc ** -0.5)),
            "w_uv": _w((lambda *s: torch.randn(*s, dtype=torch.bfloat16) * 0.8)(Dc, H, D) * (Dc ** -0.5)),
            "w_o": _w((lambda *s: torch.randn(*s, dtype=torch.bfloat16) * 0.8)(H, D, M) * ((H * D) ** -0.5)),
        }
    _A_in = _A_setup()

    def _B_setup():
        B, S, Dm, Df = 1, 1, 640, 1728
        return {
            "x": _w((lambda *s: torch.randn(*s, dtype=torch.bfloat16) * 0.05)(B, S, Dm)),
            "w_gate": _w((lambda *s: torch.randn(*s, dtype=torch.bfloat16) * 0.4)(Dm, Df) * (Dm ** -0.5)),
            "w_up": _w((lambda *s: torch.randn(*s, dtype=torch.bfloat16) * 0.4)(Dm, Df) * (Dm ** -0.5)),
            "w_down": _w((lambda *s: torch.randn(*s, dtype=torch.bfloat16) * 0.4)(Df, Dm) * (Df ** -0.5)),
        }
    _B_in = _B_setup()

    return {
        "A_x": _A_in["x"],
        "A_c_kv": _A_in["c_kv"],
        "A_w_q": _A_in["w_q"],
        "A_w_uk": _A_in["w_uk"],
        "A_w_uv": _A_in["w_uv"],
        "A_w_o": _A_in["w_o"],
        "B_x": _B_in["x"],
        "B_w_gate": _B_in["w_gate"],
        "B_w_up": _B_in["w_up"],
        "B_w_down": _B_in["w_down"],
    }

def reference(A_x, A_c_kv, A_w_q, A_w_uk, A_w_uv, A_w_o, B_x, B_w_gate, B_w_up, B_w_down):
    def _A_ref(x, c_kv, w_q, w_uk, w_uv, w_o):
        B, Sq, M = x.shape[0], x.shape[1], x.shape[2]
        Sk = c_kv.shape[1]
        H, D = w_q.shape[1], w_q.shape[2]
        q = torch.einsum("bqm,mhd->bhqd", x, w_q)
        k = torch.einsum("bkc,chd->bhkd", c_kv, w_uk)
        v = torch.einsum("bkc,chd->bhkd", c_kv, w_uv)
        scores = torch.einsum("bhqd,bhkd->bhqk", q, k) * (D ** -0.5)
        off = Sk - Sq
        qi = torch.arange(Sq)[:, None]
        kj = torch.arange(Sk)[None, :]
        cmask = kj <= (qi + off)
        scores = torch.where(cmask[None, None], scores, -1e9)
        p = _softmax(scores, axis=-1)
        ctx = torch.einsum("bhqk,bhkd->bhqd", p, v)
        return torch.einsum("bhqd,hdm->bqm", ctx, w_o)

    def _B_ref(x, w_gate, w_up, w_down):
        g = torch.einsum("bsd,df->bsf", x, w_gate)
        u = torch.einsum("bsd,df->bsf", x, w_up)
        h = _gelu(g) * u
        return torch.einsum("bsf,fd->bsd", h, w_down)

    x = A_x
    h = x + _A_ref(_layernorm(x, axis=-1), A_c_kv, A_w_q, A_w_uk, A_w_uv, A_w_o)
    h2 = h + _B_ref(_layernorm(h, axis=-1), B_w_gate, B_w_up, B_w_down)
    return h2
```

```asm
; @launch grid=(256,1,1) block=(256,1,1) lds=155648
.amdgcn_target "amdgcn-amd-amdhsa--gfx950"
.text
.globl sequential_preLN__compressed_kv_cla__glu_gated_geglu__decode_kernel
.p2align 8
.type sequential_preLN__compressed_kv_cla__glu_gated_geglu__decode_kernel,@function
sequential_preLN__compressed_kv_cla__glu_gated_geglu__decode_kernel:
s_cmp_ge_u32 s2, 256
s_cbranch_scc1 L_exit
s_load_dwordx16 s[4:19], s[0:1], 0
s_load_dwordx8 s[20:27], s[0:1], 64
s_load_dwordx2 s[28:29], s[0:1], 96
v_lshrrev_b32 v1, 6, v0
v_and_b32 v0, 63, v0
v_readfirstlane_b32 s31, v1
v_and_b32 v1, 15, v0
v_lshrrev_b32 v2, 4, v0
s_and_b32 s3, s2, 7
s_lshl_b32 s3, s3, 4
s_lshr_b32 s52, s2, 4
s_add_u32 s3, s3, s52
s_mov_b32 s60, 0x8000
s_lshr_b32 s56, s3, 2
s_and_b32 s57, s3, 3
v_lshlrev_b32 v17, 4, v0
v_and_b32 v3, 1, v1
v_lshlrev_b32 v3, 4, v3
v_mov_b32 v8, 0xffff
v_lshlrev_b32 v3, v3, v8
v_lshrrev_b32 v8, 1, v1
v_cmp_eq_u32 vcc, 0, v8
s_nop 1
v_cndmask_b32 v4, 0, v3, vcc
v_cmp_eq_u32 vcc, 1, v8
s_nop 1
v_cndmask_b32 v5, 0, v3, vcc
v_cmp_eq_u32 vcc, 2, v8
s_nop 1
v_cndmask_b32 v6, 0, v3, vcc
v_cmp_eq_u32 vcc, 3, v8
s_nop 1
v_cndmask_b32 v7, 0, v3, vcc
s_bitcmp1_b32 s2, 3
s_cbranch_scc1 L_S2
s_mul_i32 s52, s57, 160
s_mul_i32 s53, s31, 40
s_add_u32 s52, s52, s53
s_lshl_b32 s53, s52, 13
s_lshl_b32 s54, s56, 8
s_add_u32 s53, s53, s54
v_lshlrev_b32 v18, 13, v2
v_lshl_add_u32 v18, v1, 4, v18
v_lshl_add_u32 v19, v1, 2, v2
v_add_u32 v19, s52, v19
v_lshlrev_b32 v19, 1, v19
s_waitcnt lgkmcnt(0)
s_load_dword s30, s[28:29], 0
s_mov_b32 s48, s4
s_mov_b32 s49, s5
s_mov_b32 s50, 1280
s_mov_b32 s51, 0x20000
s_mov_b32 s36, s8
s_mov_b32 s37, s9
s_mov_b32 s38, 5242880
s_mov_b32 s39, 0x20000
buffer_load_dwordx4 v[8:11], v17, s[48:51], 0 offen
buffer_load_dwordx4 v[12:15], v17, s[48:51], 0 offen offset:1024
buffer_load_ushort v16, v19, s[48:51], 0 offen
buffer_load_dwordx4 v[20:23], v18, s[36:39], s53 offen
s_add_u32 s53, s53, 32768
buffer_load_dwordx4 v[24:27], v18, s[36:39], s53 offen
s_add_u32 s53, s53, 32768
buffer_load_dwordx4 v[28:31], v18, s[36:39], s53 offen
s_add_u32 s53, s53, 32768
buffer_load_dwordx4 v[32:35], v18, s[36:39], s53 offen
s_add_u32 s53, s53, 32768
buffer_load_dwordx4 v[36:39], v18, s[36:39], s53 offen
s_add_u32 s53, s53, 32768
buffer_load_dwordx4 v[40:43], v18, s[36:39], s53 offen
s_add_u32 s53, s53, 32768
buffer_load_dwordx4 v[44:47], v18, s[36:39], s53 offen
s_add_u32 s53, s53, 32768
buffer_load_dwordx4 v[48:51], v18, s[36:39], s53 offen
s_add_u32 s53, s53, 32768
buffer_load_dwordx4 v[52:55], v18, s[36:39], s53 offen
s_add_u32 s53, s53, 32768
buffer_load_dwordx4 v[56:59], v18, s[36:39], s53 offen
s_mov_b32 s32, s28
s_mov_b32 s33, s29
s_mov_b32 s34, 268435456
s_mov_b32 s35, 0x20000
s_mov_b32 s40, s6
s_mov_b32 s41, s7
s_mov_b32 s42, 8388608
s_mov_b32 s43, 0x20000
s_lshl_b32 s52, s3, 9
s_add_u32 s52, s52, 65536
v_add_u32 v19, s52, v17
s_cmp_eq_u32 s31, 0
s_cselect_b32 s52, 32, 0
v_mov_b32 v3, 2147483632
v_cmp_gt_u32 vcc, s52, v0
s_nop 1
v_cndmask_b32 v19, v3, v19, vcc
s_lshr_b32 s58, s3, 1
s_and_b32 s59, s3, 1
s_lshl_b32 s53, s58, 7
s_lshl_b32 s54, s31, 5
s_add_u32 s53, s53, s54
s_mul_i32 s55, s54, 1040
s_lshl_b32 s54, s59, 4
s_add_u32 s53, s53, s54
s_lshl_b32 s53, s53, 10
s_mov_b32 m0, s55
s_lshl_b32 s47, s59, 6
s_add_u32 s47, s47, s31
s_lshl_b32 s47, s47, 14
s_lshl_b32 s54, s58, 8
s_add_u32 s47, s47, s54
s_add_u32 s47, s47, 1048576
v_lshlrev_b32 v149, 18, v2
v_lshl_add_u32 v149, v1, 4, v149
v_mov_b32 v152, -1
v_mov_b32 v153, -1
v_mov_b32 v154, -1
v_mov_b32 v155, -1
v_mov_b32 v100, 0xff800000
v_lshlrev_b32 v101, 2, v1
v_add_u32 v101, 153856, v101
ds_write_b32 v101, v100 offset:0
s_mov_b32 s55, 0x3f803f80
s_waitcnt vmcnt(10)
v_dot2_f32_bf16 v100, v8, s55, 0
v_dot2_f32_bf16 v101, v8, v8, 0
v_dot2_f32_bf16 v100, v9, s55, v100
v_dot2_f32_bf16 v101, v9, v9, v101
v_dot2_f32_bf16 v100, v10, s55, v100
v_dot2_f32_bf16 v101, v10, v10, v101
v_dot2_f32_bf16 v100, v11, s55, v100
v_dot2_f32_bf16 v101, v11, v11, v101
v_dot2_f32_bf16 v100, v12, s55, v100
v_dot2_f32_bf16 v101, v12, v12, v101
v_dot2_f32_bf16 v100, v13, s55, v100
v_dot2_f32_bf16 v101, v13, v13, v101
v_dot2_f32_bf16 v100, v14, s55, v100
v_dot2_f32_bf16 v101, v14, v14, v101
v_dot2_f32_bf16 v100, v15, s55, v100
v_dot2_f32_bf16 v101, v15, v15, v101
s_nop 1
v_add_f32_dpp v100, v100, v100 row_ror:8 row_mask:0xf bank_mask:0xf
v_add_f32_dpp v101, v101, v101 row_ror:8 row_mask:0xf bank_mask:0xf
s_nop 0
v_add_f32_dpp v100, v100, v100 row_ror:4 row_mask:0xf bank_mask:0xf
v_add_f32_dpp v101, v101, v101 row_ror:4 row_mask:0xf bank_mask:0xf
s_nop 0
v_add_f32_dpp v100, v100, v100 row_ror:2 row_mask:0xf bank_mask:0xf
v_add_f32_dpp v101, v101, v101 row_ror:2 row_mask:0xf bank_mask:0xf
s_nop 0
v_add_f32_dpp v100, v100, v100 row_ror:1 row_mask:0xf bank_mask:0xf
v_add_f32_dpp v101, v101, v101 row_ror:1 row_mask:0xf bank_mask:0xf
v_mov_b32 v102, v100
v_mov_b32 v103, v101
s_nop 0
v_permlane16_swap_b32 v102, v100
v_permlane16_swap_b32 v103, v101
v_add_f32 v100, v102, v100
v_add_f32 v101, v103, v101
v_mov_b32 v102, v100
v_mov_b32 v103, v101
s_nop 0
v_permlane32_swap_b32 v102, v100
v_permlane32_swap_b32 v103, v101
v_add_f32 v100, v102, v100
v_add_f32 v101, v103, v101
v_mul_f32 v100, 0x3acccccd, v100
v_mul_f32 v101, 0x3acccccd, v101
v_fma_f32 v101, -v100, v100, v101
v_max_f32 v101, 0, v101
v_add_f32 v101, 0x3727c5ac, v101
v_rsq_f32 v101, v101
v_lshlrev_b32 v16, 16, v16
v_sub_f32 v16, v16, v100
v_mul_f32 v16, v16, v101
v_cvt_pk_bf16_f32 v16, v16, v16
s_nop 1
v_and_b32_dpp v60, v16, v4 row_newbcast:0 row_mask:0xf bank_mask:0xf
v_and_b32_dpp v61, v16, v5 row_newbcast:0 row_mask:0xf bank_mask:0xf
v_and_b32_dpp v62, v16, v6 row_newbcast:0 row_mask:0xf bank_mask:0xf
v_and_b32_dpp v63, v16, v7 row_newbcast:0 row_mask:0xf bank_mask:0xf
v_and_b32_dpp v64, v16, v4 row_newbcast:1 row_mask:0xf bank_mask:0xf
v_and_b32_dpp v65, v16, v5 row_newbcast:1 row_mask:0xf bank_mask:0xf
v_and_b32_dpp v66, v16, v6 row_newbcast:1 row_mask:0xf bank_mask:0xf
v_and_b32_dpp v67, v16, v7 row_newbcast:1 row_mask:0xf bank_mask:0xf
v_and_b32_dpp v68, v16, v4 row_newbcast:2 row_mask:0xf bank_mask:0xf
v_and_b32_dpp v69, v16, v5 row_newbcast:2 row_mask:0xf bank_mask:0xf
v_and_b32_dpp v70, v16, v6 row_newbcast:2 row_mask:0xf bank_mask:0xf
v_and_b32_dpp v71, v16, v7 row_newbcast:2 row_mask:0xf bank_mask:0xf
v_and_b32_dpp v72, v16, v4 row_newbcast:3 row_mask:0xf bank_mask:0xf
v_and_b32_dpp v73, v16, v5 row_newbcast:3 row_mask:0xf bank_mask:0xf
v_and_b32_dpp v74, v16, v6 row_newbcast:3 row_mask:0xf bank_mask:0xf
v_and_b32_dpp v75, v16, v7 row_newbcast:3 row_mask:0xf bank_mask:0xf
v_and_b32_dpp v76, v16, v4 row_newbcast:4 row_mask:0xf bank_mask:0xf
v_and_b32_dpp v77, v16, v5 row_newbcast:4 row_mask:0xf bank_mask:0xf
v_and_b32_dpp v78, v16, v6 row_newbcast:4 row_mask:0xf bank_mask:0xf
v_and_b32_dpp v79, v16, v7 row_newbcast:4 row_mask:0xf bank_mask:0xf
v_and_b32_dpp v80, v16, v4 row_newbcast:5 row_mask:0xf bank_mask:0xf
v_and_b32_dpp v81, v16, v5 row_newbcast:5 row_mask:0xf bank_mask:0xf
v_and_b32_dpp v82, v16, v6 row_newbcast:5 row_mask:0xf bank_mask:0xf
v_and_b32_dpp v83, v16, v7 row_newbcast:5 row_mask:0xf bank_mask:0xf
v_and_b32_dpp v84, v16, v4 row_newbcast:6 row_mask:0xf bank_mask:0xf
v_and_b32_dpp v85, v16, v5 row_newbcast:6 row_mask:0xf bank_mask:0xf
v_and_b32_dpp v86, v16, v6 row_newbcast:6 row_mask:0xf bank_mask:0xf
v_and_b32_dpp v87, v16, v7 row_newbcast:6 row_mask:0xf bank_mask:0xf
v_and_b32_dpp v88, v16, v4 row_newbcast:7 row_mask:0xf bank_mask:0xf
v_and_b32_dpp v89, v16, v5 row_newbcast:7 row_mask:0xf bank_mask:0xf
v_and_b32_dpp v90, v16, v6 row_newbcast:7 row_mask:0xf bank_mask:0xf
v_and_b32_dpp v91, v16, v7 row_newbcast:7 row_mask:0xf bank_mask:0xf
v_and_b32_dpp v92, v16, v4 row_newbcast:8 row_mask:0xf bank_mask:0xf
v_and_b32_dpp v93, v16, v5 row_newbcast:8 row_mask:0xf bank_mask:0xf
v_and_b32_dpp v94, v16, v6 row_newbcast:8 row_mask:0xf bank_mask:0xf
v_and_b32_dpp v95, v16, v7 row_newbcast:8 row_mask:0xf bank_mask:0xf
v_and_b32_dpp v96, v16, v4 row_newbcast:9 row_mask:0xf bank_mask:0xf
v_and_b32_dpp v97, v16, v5 row_newbcast:9 row_mask:0xf bank_mask:0xf
v_and_b32_dpp v98, v16, v6 row_newbcast:9 row_mask:0xf bank_mask:0xf
v_and_b32_dpp v99, v16, v7 row_newbcast:9 row_mask:0xf bank_mask:0xf
v_lshl_add_u32 v3, v1, 1, v2
v_lshlrev_b32 v3, 4, v3
s_lshl_b32 s54, s31, 9
s_add_u32 s54, s54, 149760
v_add_u32 v3, s54, v3
v_mov_b32 v16, 0xff
s_waitcnt lgkmcnt(0)
s_mul_i32 s30, s30, 0x9E3779B5
s_add_u32 s30, s30, 0x7F4A7C15
s_waitcnt vmcnt(9)
v_mfma_f32_16x16x32_bf16 v[100:103], v[60:63], v[20:23], 0
s_waitcnt vmcnt(8)
v_mfma_f32_16x16x32_bf16 v[100:103], v[64:67], v[24:27], v[100:103]
s_waitcnt vmcnt(7)
v_mfma_f32_16x16x32_bf16 v[100:103], v[68:71], v[28:31], v[100:103]
s_waitcnt vmcnt(6)
v_mfma_f32_16x16x32_bf16 v[100:103], v[72:75], v[32:35], v[100:103]
s_waitcnt vmcnt(5)
v_mfma_f32_16x16x32_bf16 v[100:103], v[76:79], v[36:39], v[100:103]
s_waitcnt vmcnt(4)
v_mfma_f32_16x16x32_bf16 v[100:103], v[80:83], v[40:43], v[100:103]
s_waitcnt vmcnt(3)
v_mfma_f32_16x16x32_bf16 v[100:103], v[84:87], v[44:47], v[100:103]
s_waitcnt vmcnt(2)
v_mfma_f32_16x16x32_bf16 v[100:103], v[88:91], v[48:51], v[100:103]
buffer_load_dwordx4 v17, s[40:43], s53 offen offset:0  lds
s_add_u32 m0, m0, 16
s_waitcnt vmcnt(2)
v_mfma_f32_16x16x32_bf16 v[100:103], v[92:95], v[52:55], v[100:103]
buffer_load_dwordx4 v17, s[40:43], s53 offen offset:1024  lds
s_add_u32 m0, m0, 16
s_waitcnt vmcnt(2)
v_mfma_f32_16x16x32_bf16 v[100:103], v[96:99], v[56:59], v[100:103]
buffer_load_dwordx4 v17, s[40:43], s53 offen offset:2048  lds
s_add_u32 m0, m0, 16
s_mov_b32 exec_hi, 0
s_nop 4
ds_write_b128 v3, v[100:103]
s_mov_b64 exec, -1
s_waitcnt lgkmcnt(0)
s_barrier
s_cmp_lg_u32 s31, 0
s_cbranch_scc1 L_nopub
v_add_u32 v3, 149760, v17
ds_read_b128 v[20:23], v3
ds_read_b128 v[24:27], v3 offset:512
ds_read_b128 v[28:31], v3 offset:1024
ds_read_b128 v[32:35], v3 offset:1536
s_lshr_b32 s52, s30, 8
s_lshr_b32 s54, s30, 16
s_lshr_b32 s55, s30, 24
s_waitcnt lgkmcnt(2)
v_pk_add_f32 v[20:21], v[20:21], v[24:25]
v_pk_add_f32 v[22:23], v[22:23], v[26:27]
s_waitcnt lgkmcnt(0)
v_pk_add_f32 v[28:29], v[28:29], v[32:33]
v_pk_add_f32 v[30:31], v[30:31], v[34:35]
v_pk_add_f32 v[20:21], v[20:21], v[28:29]
v_pk_add_f32 v[22:23], v[22:23], v[30:31]
v_bfi_b32 v20, v16, s30, v20
v_bfi_b32 v21, v16, s52, v21
v_bfi_b32 v22, v16, s54, v22
v_bfi_b32 v23, v16, s55, v23
s_mov_b32 s52, 720896
buffer_store_dwordx4 v[20:23], v19, s[32:35], 0 offen
buffer_store_dwordx4 v[20:23], v19, s[32:35], s52 offen sc1
L_nopub:
s_barrier
v_and_b32 v18, 1, v2
v_xor_b32 v18, s59, v18
v_lshl_add_u32 v18, v18, 6, v1
v_lshlrev_b32 v18, 7, v18
s_lshl_b32 s52, s31, 11
s_add_u32 s52, s52, 163840
buffer_load_dwordx4 v17, s[40:43], s53 offen offset:3072  lds
s_add_u32 m0, m0, 4112
s_add_u32 s53, s53, 4096
buffer_load_dwordx4 v17, s[40:43], s53 offen offset:0  lds
s_add_u32 m0, m0, 16
s_nop 0
buffer_load_dwordx4 v17, s[40:43], s53 offen offset:1024  lds
s_add_u32 m0, m0, 16
s_nop 0
buffer_load_dwordx4 v17, s[40:43], s53 offen offset:2048  lds
s_add_u32 m0, m0, 16
s_nop 0
buffer_load_dwordx4 v17, s[40:43], s53 offen offset:3072  lds
s_add_u32 m0, m0, 4112
s_add_u32 s53, s53, 4096
buffer_load_dwordx4 v17, s[40:43], s53 offen offset:0  lds
s_add_u32 m0, m0, 16
s_nop 0
buffer_load_dwordx4 v17, s[40:43], s53 offen offset:1024  lds
s_add_u32 m0, m0, 16
s_nop 0
buffer_load_dwordx4 v17, s[40:43], s53 offen offset:2048  lds
s_add_u32 m0, m0, 16
s_nop 0
buffer_load_dwordx4 v17, s[40:43], s53 offen offset:3072  lds
s_add_u32 m0, m0, 4112
s_add_u32 s53, s53, 4096
buffer_load_dwordx4 v17, s[40:43], s53 offen offset:0  lds
s_add_u32 m0, m0, 16
s_nop 0
buffer_load_dwordx4 v17, s[40:43], s53 offen offset:1024  lds
s_add_u32 m0, m0, 16
s_nop 0
buffer_load_dwordx4 v17, s[40:43], s53 offen offset:2048  lds
s_add_u32 m0, m0, 16
s_nop 0
buffer_load_dwordx4 v17, s[40:43], s53 offen offset:3072  lds
s_add_u32 m0, m0, 4112
s_sub_u32 s53, s53, 12288
s_xor_b32 s53, s53, 16384
buffer_load_dwordx4 v17, s[40:43], s53 offen offset:0  lds
s_add_u32 m0, m0, 16
s_waitcnt vmcnt(16)
buffer_load_dwordx4 v17, s[40:43], s53 offen offset:1024  lds
s_add_u32 m0, m0, 16
s_waitcnt vmcnt(16)
buffer_load_dword v8, v18, s[32:35], s52 offen sc1
buffer_load_dwordx4 v17, s[40:43], s53 offen offset:2048  lds
s_add_u32 m0, m0, 16
s_waitcnt vmcnt(16)
buffer_load_dwordx4 v17, s[40:43], s53 offen offset:3072  lds
s_add_u32 m0, m0, 4112
s_add_u32 s53, s53, 4096
s_waitcnt vmcnt(16)
buffer_load_dwordx4 v17, s[40:43], s53 offen offset:0  lds
s_add_u32 m0, m0, 16
s_waitcnt vmcnt(16)
buffer_load_dwordx4 v17, s[40:43], s53 offen offset:1024  lds
s_add_u32 m0, m0, 16
s_waitcnt vmcnt(16)
buffer_load_dwordx4 v17, s[40:43], s53 offen offset:2048  lds
s_add_u32 m0, m0, 16
s_waitcnt vmcnt(16)
buffer_load_dwordx4 v17, s[40:43], s53 offen offset:3072  lds
s_add_u32 m0, m0, 4112
s_add_u32 s53, s53, 4096
s_waitcnt vmcnt(16)
buffer_load_dwordx4 v17, s[40:43], s53 offen offset:0  lds
s_add_u32 m0, m0, 16
s_waitcnt vmcnt(16)
buffer_load_dwordx4 v17, s[40:43], s53 offen offset:1024  lds
s_add_u32 m0, m0, 16
s_waitcnt vmcnt(16)
buffer_load_dwordx4 v17, s[40:43], s53 offen offset:2048  lds
s_add_u32 m0, m0, 16
s_waitcnt vmcnt(16)
buffer_load_dwordx4 v17, s[40:43], s53 offen offset:3072  lds
s_add_u32 m0, m0, 4112
s_add_u32 s53, s53, 4096
s_waitcnt vmcnt(16)
buffer_load_dwordx4 v17, s[40:43], s53 offen offset:0  lds
s_add_u32 m0, m0, 16
s_waitcnt vmcnt(16)
buffer_load_dwordx4 v17, s[40:43], s53 offen offset:1024  lds
s_add_u32 m0, m0, 16
s_waitcnt vmcnt(16)
buffer_load_dwordx4 v17, s[40:43], s53 offen offset:2048  lds
s_add_u32 m0, m0, 16
s_waitcnt vmcnt(16)
buffer_load_dwordx4 v17, s[40:43], s53 offen offset:3072  lds
s_add_u32 m0, m0, 4112
s_add_u32 s53, s53, 4096
s_mov_b32 s54, 1040
s_mul_i32 s55, s31, 33280
v_lshlrev_b32 v3, 8, v2
v_mad_u32_u24 v13, v1, s54, v3
v_add_u32 v10, s55, v13
v_add_u32 v13, 133120, v13
v_lshrrev_b32 v11, 2, v0
v_mul_u32_u24 v11, s54, v11
v_and_b32 v3, 1, v0
v_lshl_add_u32 v11, v3, 3, v11
v_bfe_u32 v3, v0, 1, 1
v_lshl_add_u32 v11, v3, 7, v11
s_lshl_b32 s55, s31, 8
v_add_u32 v11, s55, v11
v_add_u32 v12, 66560, v11
s_mul_i32 s61, s31, 4160
s_add_u32 s61, s61, 133120
v_add_u32 v14, s61, v17
s_lshl_b32 s53, s59, 14
s_lshl_b32 s55, s31, 12
s_add_u32 s53, s53, s55
s_add_u32 s53, s53, 131072
s_and_b32 s57, s3, 15
s_lshr_b32 s56, s3, 4
v_lshrrev_b32 v140, 3, v0
v_and_b32 v141, 4, v140
v_bfe_u32 v142, v140, 1, 1
v_add_u32 v141, v141, v142
v_and_b32 v142, 1, v140
v_lshl_add_u32 v141, v142, 4, v141
v_mul_u32_u24 v141, 1280, v141
v_and_b32 v142, 6, v140
v_and_b32 v140, 7, v0
v_xor_b32 v140, v140, v142
v_lshl_add_u32 v141, v140, 4, v141
s_cmp_lt_u32 s57, 10
s_cselect_b32 s54, 0, 2147483632
v_max_u32 v141, s54, v141
s_lshl_b32 s44, s56, 2
s_add_u32 s44, s44, s31
s_mul_i32 s45, s44, 163840
s_lshl_b32 s54, s57, 7
s_add_u32 s45, s45, s54
s_mul_i32 s46, s31, 33280
v_lshlrev_b32 v148, 2, v1
v_add_u32 v148, 153856, v148
s_lshl_b32 s54, s31, 10
s_add_u32 s54, s54, 149760
v_add_u32 v15, s54, v17
v_add_u32 v16, 149760, v17
s_cmp_eq_u32 s31, 0
s_cselect_b32 s55, 16, 0
v_lshlrev_b32 v150, 3, v1
v_lshrrev_b32 v151, 2, v1
v_mul_u32_u24 v151, 96, v151
v_add_u32 v150, v150, v151
v_mov_b32 v151, 2147483632
v_cmp_gt_u32 vcc, s55, v0
s_nop 1
v_cndmask_b32 v150, v151, v150, vcc
s_lshl_b32 s55, s3, 9
s_add_u32 s55, s55, 196608
v_mov_b32 v144, 0x3f803f80
v_mov_b32 v145, 0x3f803f80
v_mov_b32 v146, 0x3f803f80
v_mov_b32 v147, 0x3f803f80
s_mov_b32 s36, s14
s_mov_b32 s37, s15
s_mov_b32 s38, 5242880
s_mov_b32 s39, 0x20000
s_waitcnt vmcnt(14)
v_cmp_ne_u32 vcc, s30, v8
s_cbranch_vccz L_flok
L_flp:
buffer_load_dword v8, v18, s[32:35], s52 offen sc1
s_sub_u32 s60, s60, 1
s_cbranch_scc1 L_end
s_waitcnt vmcnt(0)
v_cmp_ne_u32 vcc, s30, v8
s_cbranch_vccnz L_flp
L_flok:
s_waitcnt vmcnt(10)
s_mov_b32 m0, s61
s_nop 0
buffer_load_dwordx4 v17, s[32:35], s53 offen offset:0 sc1 lds
s_add_u32 m0, m0, 16
s_nop 0
buffer_load_dwordx4 v17, s[32:35], s53 offen offset:1024 sc1 lds
s_add_u32 m0, m0, 16
s_nop 0
buffer_load_dwordx4 v17, s[32:35], s53 offen offset:2048 sc1 lds
s_add_u32 m0, m0, 16
s_nop 0
buffer_load_dwordx4 v17, s[32:35], s53 offen offset:3072 sc1 lds
s_waitcnt vmcnt(20)
ds_read_b128 a[0:3], v10 offset:0
ds_read_b128 a[4:7], v10 offset:16
ds_read_b128 a[8:11], v10 offset:32
ds_read_b128 a[12:15], v10 offset:48
ds_read_b128 a[16:19], v10 offset:64
ds_read_b128 a[20:23], v10 offset:80
ds_read_b128 a[24:27], v10 offset:96
ds_read_b128 a[28:31], v10 offset:112
ds_read_b128 a[32:35], v10 offset:128
ds_read_b128 a[36:39], v10 offset:144
ds_read_b128 a[40:43], v10 offset:160
ds_read_b128 a[44:47], v10 offset:176
ds_read_b128 a[48:51], v10 offset:192
ds_read_b128 a[52:55], v10 offset:208
ds_read_b128 a[56:59], v10 offset:224
ds_read_b128 a[60:63], v10 offset:240
s_barrier
ds_read_b64_tr_b16 a[128:129], v11 offset:0
ds_read_b64_tr_b16 a[144:145], v11 offset:16
ds_read_b64_tr_b16 a[160:161], v11 offset:32
ds_read_b64_tr_b16 a[176:177], v11 offset:48
ds_read_b64_tr_b16 a[192:193], v11 offset:64
ds_read_b64_tr_b16 a[208:209], v11 offset:80
ds_read_b64_tr_b16 a[224:225], v11 offset:96
ds_read_b64_tr_b16 a[240:241], v11 offset:112
ds_read_b64_tr_b16 a[132:133], v11 offset:33280
ds_read_b64_tr_b16 a[148:149], v11 offset:33296
ds_read_b64_tr_b16 a[164:165], v11 offset:33312
ds_read_b64_tr_b16 a[180:181], v11 offset:33328
ds_read_b64_tr_b16 a[196:197], v11 offset:33344
ds_read_b64_tr_b16 a[212:213], v11 offset:33360
ds_read_b64_tr_b16 a[228:229], v11 offset:33376
ds_read_b64_tr_b16 a[244:245], v11 offset:33392
ds_read_b64_tr_b16 a[136:137], v12 offset:0
ds_read_b64_tr_b16 a[152:153], v12 offset:16
ds_read_b64_tr_b16 a[168:169], v12 offset:32
ds_read_b64_tr_b16 a[184:185], v12 offset:48
ds_read_b64_tr_b16 a[200:201], v12 offset:64
ds_read_b64_tr_b16 a[216:217], v12 offset:80
ds_read_b64_tr_b16 a[232:233], v12 offset:96
ds_read_b64_tr_b16 a[248:249], v12 offset:112
ds_read_b64_tr_b16 a[140:141], v12 offset:33280
ds_read_b64_tr_b16 a[156:157], v12 offset:33296
ds_read_b64_tr_b16 a[172:173], v12 offset:33312
ds_read_b64_tr_b16 a[188:189], v12 offset:33328
ds_read_b64_tr_b16 a[204:205], v12 offset:33344
ds_read_b64_tr_b16 a[220:221], v12 offset:33360
ds_read_b64_tr_b16 a[236:237], v12 offset:33376
ds_read_b64_tr_b16 a[252:253], v12 offset:33392
s_waitcnt vmcnt(4)
s_waitcnt lgkmcnt(0)
ds_read_b128 a[64:67], v10 offset:16640
ds_read_b128 a[68:71], v10 offset:16656
ds_read_b128 a[72:75], v10 offset:16672
ds_read_b128 a[76:79], v10 offset:16688
ds_read_b128 a[80:83], v10 offset:16704
ds_read_b128 a[84:87], v10 offset:16720
ds_read_b128 a[88:91], v10 offset:16736
ds_read_b128 a[92:95], v10 offset:16752
s_waitcnt vmcnt(0)
ds_read_b32 v84, v14 offset:12
ds_read_b32 v85, v14 offset:1052
ds_read_b32 v86, v14 offset:2092
ds_read_b32 v87, v14 offset:3132
ds_read_b128 a[96:99], v10 offset:16768
ds_read_b128 a[100:103], v10 offset:16784
ds_read_b128 a[104:107], v10 offset:16800
ds_read_b128 a[108:111], v10 offset:16816
ds_read_b128 a[112:115], v10 offset:16832
ds_read_b128 a[116:119], v10 offset:16848
ds_read_b128 a[120:123], v10 offset:16864
ds_read_b128 a[124:127], v10 offset:16880
s_waitcnt lgkmcnt(8)
v_max3_u32 v3, v84, v85, v86
v_max_u32 v3, v3, v87
v_cmp_eq_u32 vcc, -1, v3
s_cbranch_vccz L_qok
L_qp:
s_sub_u32 s60, s60, 1
s_mov_b32 m0, s61
v_cmp_eq_u32 s[6:7], -1, v84
v_cmp_eq_u32 s[8:9], -1, v85
v_cmp_eq_u32 s[10:11], -1, v86
v_cmp_eq_u32 s[12:13], -1, v87
s_nop 3
s_mov_b64 exec, s[6:7]
buffer_load_dwordx4 v17, s[32:35], s53 offen offset:0 sc1 lds
s_add_u32 m0, m0, 16
s_mov_b64 exec, s[8:9]
buffer_load_dwordx4 v17, s[32:35], s53 offen offset:1024 sc1 lds
s_add_u32 m0, m0, 16
s_mov_b64 exec, s[10:11]
buffer_load_dwordx4 v17, s[32:35], s53 offen offset:2048 sc1 lds
s_add_u32 m0, m0, 16
s_mov_b64 exec, s[12:13]
buffer_load_dwordx4 v17, s[32:35], s53 offen offset:3072 sc1 lds
s_mov_b64 exec, -1
s_cmp_eq_u32 s60, -1
s_cbranch_scc1 L_end
s_waitcnt vmcnt(0)
L_qchk:
ds_read_b32 v84, v14 offset:12
ds_read_b32 v85, v14 offset:1052
ds_read_b32 v86, v14 offset:2092
ds_read_b32 v87, v14 offset:3132
s_waitcnt lgkmcnt(0)
v_max3_u32 v3, v84, v85, v86
v_max_u32 v3, v3, v87
v_cmp_eq_u32 vcc, -1, v3
s_cbranch_vccnz L_qp
L_qok:
s_add_u32 s54, s47, 0
buffer_store_dwordx4 v[152:155], v149, s[32:35], s54 offen sc1
s_add_u32 s54, s47, 65536
buffer_store_dwordx4 v[152:155], v149, s[32:35], s54 offen sc1
s_add_u32 s54, s47, 131072
buffer_store_dwordx4 v[152:155], v149, s[32:35], s54 offen sc1
s_add_u32 s54, s47, 196608
buffer_store_dwordx4 v[152:155], v149, s[32:35], s54 offen sc1
s_barrier
ds_read_b128 v[20:23], v13 offset:0
ds_read_b128 v[24:27], v13 offset:16
ds_read_b128 v[28:31], v13 offset:32
ds_read_b128 v[32:35], v13 offset:48
ds_read_b128 v[36:39], v13 offset:64
s_waitcnt lgkmcnt(4)
v_mfma_f32_16x16x32_bf16 v[84:87], a[0:3], v[20:23], 0
v_mfma_f32_16x16x32_bf16 v[88:91], a[64:67], v[20:23], 0
ds_read_b128 v[40:43], v13 offset:80
s_waitcnt lgkmcnt(4)
v_mfma_f32_16x16x32_bf16 v[84:87], a[4:7], v[24:27], v[84:87]
v_mfma_f32_16x16x32_bf16 v[88:91], a[68:71], v[24:27], v[88:91]
ds_read_b128 v[44:47], v13 offset:96
s_waitcnt lgkmcnt(4)
v_mfma_f32_16x16x32_bf16 v[84:87], a[8:11], v[28:31], v[84:87]
v_mfma_f32_16x16x32_bf16 v[88:91], a[72:75], v[28:31], v[88:91]
ds_read_b128 v[48:51], v13 offset:112
s_waitcnt lgkmcnt(4)
v_mfma_f32_16x16x32_bf16 v[84:87], a[12:15], v[32:35], v[84:87]
v_mfma_f32_16x16x32_bf16 v[88:91], a[76:79], v[32:35], v[88:91]
ds_read_b128 v[52:55], v13 offset:128
s_waitcnt lgkmcnt(4)
v_mfma_f32_16x16x32_bf16 v[84:87], a[16:19], v[36:39], v[84:87]
v_mfma_f32_16x16x32_bf16 v[88:91], a[80:83], v[36:39], v[88:91]
ds_read_b128 v[56:59], v13 offset:144
s_waitcnt lgkmcnt(4)
v_mfma_f32_16x16x32_bf16 v[84:87], a[20:23], v[40:43], v[84:87]
v_mfma_f32_16x16x32_bf16 v[88:91], a[84:87], v[40:43], v[88:91]
ds_read_b128 v[60:63], v13 offset:160
s_waitcnt lgkmcnt(4)
v_mfma_f32_16x16x32_bf16 v[84:87], a[24:27], v[44:47], v[84:87]
v_mfma_f32_16x16x32_bf16 v[88:91], a[88:91], v[44:47], v[88:91]
ds_read_b128 v[64:67], v13 offset:176
s_waitcnt lgkmcnt(4)
v_mfma_f32_16x16x32_bf16 v[84:87], a[28:31], v[48:51], v[84:87]
v_mfma_f32_16x16x32_bf16 v[88:91], a[92:95], v[48:51], v[88:91]
ds_read_b128 v[68:71], v13 offset:192
s_waitcnt lgkmcnt(4)
v_mfma_f32_16x16x32_bf16 v[84:87], a[32:35], v[52:55], v[84:87]
v_mfma_f32_16x16x32_bf16 v[88:91], a[96:99], v[52:55], v[88:91]
ds_read_b128 v[72:75], v13 offset:208
s_waitcnt lgkmcnt(4)
v_mfma_f32_16x16x32_bf16 v[84:87], a[36:39], v[56:59], v[84:87]
v_mfma_f32_16x16x32_bf16 v[88:91], a[100:103], v[56:59], v[88:91]
ds_read_b128 v[76:79], v13 offset:224
s_waitcnt lgkmcnt(4)
v_mfma_f32_16x16x32_bf16 v[84:87], a[40:43], v[60:63], v[84:87]
v_mfma_f32_16x16x32_bf16 v[88:91], a[104:107], v[60:63], v[88:91]
ds_read_b128 v[80:83], v13 offset:240
s_waitcnt lgkmcnt(4)
v_mfma_f32_16x16x32_bf16 v[84:87], a[44:47], v[64:67], v[84:87]
v_mfma_f32_16x16x32_bf16 v[88:91], a[108:111], v[64:67], v[88:91]
s_waitcnt lgkmcnt(3)
v_mfma_f32_16x16x32_bf16 v[84:87], a[48:51], v[68:71], v[84:87]
v_mfma_f32_16x16x32_bf16 v[88:91], a[112:115], v[68:71], v[88:91]
s_waitcnt lgkmcnt(2)
v_mfma_f32_16x16x32_bf16 v[84:87], a[52:55], v[72:75], v[84:87]
v_mfma_f32_16x16x32_bf16 v[88:91], a[116:119], v[72:75], v[88:91]
s_waitcnt lgkmcnt(1)
v_mfma_f32_16x16x32_bf16 v[84:87], a[56:59], v[76:79], v[84:87]
v_mfma_f32_16x16x32_bf16 v[88:91], a[120:123], v[76:79], v[88:91]
s_waitcnt lgkmcnt(0)
v_mfma_f32_16x16x32_bf16 v[84:87], a[60:63], v[80:83], v[84:87]
v_mfma_f32_16x16x32_bf16 v[88:91], a[124:127], v[80:83], v[88:91]
s_nop 6
v_max3_f32 v92, v84, v85, v86
v_max3_f32 v92, v92, v87, v88
v_max3_f32 v92, v92, v89, v90
v_max_f32 v92, v92, v91
ds_max_f32 v148, v92
ds_read_b64_tr_b16 a[130:131], v11 offset:16640
ds_read_b64_tr_b16 a[146:147], v11 offset:16656
ds_read_b64_tr_b16 a[134:135], v11 offset:49920
ds_read_b64_tr_b16 a[150:151], v11 offset:49936
ds_read_b64_tr_b16 a[138:139], v12 offset:16640
ds_read_b64_tr_b16 a[154:155], v12 offset:16656
s_add_u32 m0, s46, 0
s_nop 0
buffer_load_dwordx4 v141, s[36:39], s45 offen  lds
s_add_u32 s45, s45, 10240
s_add_u32 m0, s46, 1024
s_nop 0
buffer_load_dwordx4 v141, s[36:39], s45 offen  lds
s_waitcnt lgkmcnt(6)
s_barrier
ds_read_b32 v8, v148
ds_read_b64_tr_b16 a[142:143], v12 offset:49920
ds_read_b64_tr_b16 a[158:159], v12 offset:49936
ds_read_b64_tr_b16 a[162:163], v11 offset:16672
ds_read_b64_tr_b16 a[178:179], v11 offset:16688
ds_read_b64_tr_b16 a[166:167], v11 offset:49952
ds_read_b64_tr_b16 a[182:183], v11 offset:49968
ds_read_b64_tr_b16 a[170:171], v12 offset:16672
ds_read_b64_tr_b16 a[186:187], v12 offset:16688
ds_read_b64_tr_b16 a[174:175], v12 offset:49952
ds_read_b64_tr_b16 a[190:191], v12 offset:49968
s_add_u32 s45, s45, 4294959616
s_add_u32 m0, s46, 2048
s_nop 0
buffer_load_dwordx4 v141, s[36:39], s45 offen  lds
s_add_u32 s45, s45, 10240
s_add_u32 m0, s46, 3072
s_nop 0
buffer_load_dwordx4 v141, s[36:39], s45 offen  lds
s_waitcnt lgkmcnt(10)
v_sub_f32 v84, v84, v8
v_sub_f32 v85, v85, v8
v_sub_f32 v86, v86, v8
v_sub_f32 v87, v87, v8
v_sub_f32 v88, v88, v8
v_sub_f32 v89, v89, v8
v_sub_f32 v90, v90, v8
v_sub_f32 v91, v91, v8
v_exp_f32 v84, v84
v_exp_f32 v85, v85
v_exp_f32 v86, v86
v_exp_f32 v87, v87
v_exp_f32 v88, v88
v_exp_f32 v89, v89
v_exp_f32 v90, v90
v_exp_f32 v91, v91
v_cvt_pk_bf16_f32 v92, v84, v85
v_cvt_pk_bf16_f32 v93, v86, v87
v_cvt_pk_bf16_f32 v94, v88, v89
v_cvt_pk_bf16_f32 v95, v90, v91
ds_write_b128 v15, v[92:95]
s_waitcnt vmcnt(4)
s_waitcnt lgkmcnt(0)
s_barrier
ds_read_b128 v[92:95], v16 offset:0
ds_read_b128 v[96:99], v16 offset:1024
ds_read_b128 v[100:103], v16 offset:2048
ds_read_b128 v[104:107], v16 offset:3072
ds_read_b64_tr_b16 a[194:195], v11 offset:16704
ds_read_b64_tr_b16 a[210:211], v11 offset:16720
ds_read_b64_tr_b16 a[198:199], v11 offset:49984
ds_read_b64_tr_b16 a[214:215], v11 offset:50000
ds_read_b64_tr_b16 a[202:203], v12 offset:16704
ds_read_b64_tr_b16 a[218:219], v12 offset:16720
ds_read_b64_tr_b16 a[206:207], v12 offset:49984
ds_read_b64_tr_b16 a[222:223], v12 offset:50000
s_waitcnt lgkmcnt(11)
v_mfma_f32_16x16x32_bf16 v[84:87], v[144:147], v[92:95], 0
v_mfma_f32_16x16x32_bf16 v[108:111], v[92:95], a[128:131], 0
v_mfma_f32_16x16x32_bf16 v[112:115], v[92:95], a[144:147], 0
ds_read_b64_tr_b16 a[226:227], v11 offset:16736
ds_read_b64_tr_b16 a[242:243], v11 offset:16752
s_waitcnt lgkmcnt(12)
v_mfma_f32_16x16x32_bf16 v[84:87], v[144:147], v[96:99], v[84:87]
v_mfma_f32_16x16x32_bf16 v[108:111], v[96:99], a[132:135], v[108:111]
v_mfma_f32_16x16x32_bf16 v[112:115], v[96:99], a[148:151], v[112:115]
ds_read_b64_tr_b16 a[230:231], v11 offset:50016
ds_read_b64_tr_b16 a[246:247], v11 offset:50032
s_waitcnt lgkmcnt(13)
v_mfma_f32_16x16x32_bf16 v[84:87], v[144:147], v[100:103], v[84:87]
v_mfma_f32_16x16x32_bf16 v[108:111], v[100:103], a[136:139], v[108:111]
v_mfma_f32_16x16x32_bf16 v[112:115], v[100:103], a[152:155], v[112:115]
ds_read_b64_tr_b16 a[234:235], v12 offset:16736
ds_read_b64_tr_b16 a[250:251], v12 offset:16752
s_waitcnt lgkmcnt(14)
v_mfma_f32_16x16x32_bf16 v[84:87], v[144:147], v[104:107], v[84:87]
v_mfma_f32_16x16x32_bf16 v[108:111], v[104:107], a[140:143], v[108:111]
v_mfma_f32_16x16x32_bf16 v[112:115], v[104:107], a[156:159], v[112:115]
ds_read_b64_tr_b16 a[238:239], v12 offset:50016
ds_read_b64_tr_b16 a[254:255], v12 offset:50032
v_mfma_f32_16x16x32_bf16 v[116:119], v[92:95], a[160:163], 0
v_mfma_f32_16x16x32_bf16 v[120:123], v[92:95], a[176:179], 0
s_nop 1
v_mov_b32 v9, v84
buffer_store_dwordx2 v[8:9], v150, s[32:35], s55 offen sc1
v_mfma_f32_16x16x32_bf16 v[116:119], v[96:99], a[164:167], v[116:119]
v_mfma_f32_16x16x32_bf16 v[120:123], v[96:99], a[180:183], v[120:123]
v_cvt_pk_bf16_f32 v20, v108, v112
v_cvt_pk_bf16_f32 v24, v109, v113
v_cvt_pk_bf16_f32 v28, v110, v114
v_cvt_pk_bf16_f32 v32, v111, v115
v_mfma_f32_16x16x32_bf16 v[116:119], v[100:103], a[168:171], v[116:119]
v_mfma_f32_16x16x32_bf16 v[120:123], v[100:103], a[184:187], v[120:123]
v_mfma_f32_16x16x32_bf16 v[116:119], v[104:107], a[172:175], v[116:119]
v_mfma_f32_16x16x32_bf16 v[120:123], v[104:107], a[188:191], v[120:123]
s_waitcnt lgkmcnt(15)
v_mfma_f32_16x16x32_bf16 v[124:127], v[92:95], a[192:195], 0
s_waitcnt lgkmcnt(14)
v_mfma_f32_16x16x32_bf16 v[128:131], v[92:95], a[208:211], 0
s_waitcnt lgkmcnt(13)
v_mfma_f32_16x16x32_bf16 v[124:127], v[96:99], a[196:199], v[124:127]
s_waitcnt lgkmcnt(12)
v_mfma_f32_16x16x32_bf16 v[128:131], v[96:99], a[212:215], v[128:131]
v_cvt_pk_bf16_f32 v21, v116, v120
v_cvt_pk_bf16_f32 v25, v117, v121
v_cvt_pk_bf16_f32 v29, v118, v122
v_cvt_pk_bf16_f32 v33, v119, v123
s_waitcnt lgkmcnt(11)
v_mfma_f32_16x16x32_bf16 v[124:127], v[100:103], a[200:203], v[124:127]
s_waitcnt lgkmcnt(10)
v_mfma_f32_16x16x32_bf16 v[128:131], v[100:103], a[216:219], v[128:131]
s_waitcnt lgkmcnt(9)
v_mfma_f32_16x16x32_bf16 v[124:127], v[104:107], a[204:207], v[124:127]
s_waitcnt lgkmcnt(8)
v_mfma_f32_16x16x32_bf16 v[128:131], v[104:107], a[220:223], v[128:131]
s_waitcnt lgkmcnt(7)
v_mfma_f32_16x16x32_bf16 v[132:135], v[92:95], a[224:227], 0
s_waitcnt lgkmcnt(6)
v_mfma_f32_16x16x32_bf16 v[136:139], v[92:95], a[240:243], 0
s_waitcnt lgkmcnt(5)
v_mfma_f32_16x16x32_bf16 v[132:135], v[96:99], a[228:231], v[132:135]
s_waitcnt lgkmcnt(4)
v_mfma_f32_16x16x32_bf16 v[136:139], v[96:99], a[244:247], v[136:139]
v_cvt_pk_bf16_f32 v22, v124, v128
v_cvt_pk_bf16_f32 v26, v125, v129
v_cvt_pk_bf16_f32 v30, v126, v130
v_cvt_pk_bf16_f32 v34, v127, v131
s_waitcnt lgkmcnt(3)
v_mfma_f32_16x16x32_bf16 v[132:135], v[100:103], a[232:235], v[132:135]
s_waitcnt lgkmcnt(2)
v_mfma_f32_16x16x32_bf16 v[136:139], v[100:103], a[248:251], v[136:139]
s_waitcnt lgkmcnt(1)
v_mfma_f32_16x16x32_bf16 v[132:135], v[104:107], a[236:239], v[132:135]
s_waitcnt lgkmcnt(0)
v_mfma_f32_16x16x32_bf16 v[136:139], v[104:107], a[252:255], v[136:139]
s_nop 7
v_cvt_pk_bf16_f32 v23, v132, v136
buffer_store_dwordx4 v[20:23], v149, s[32:35], s47 offen sc1
s_add_u32 s47, s47, 65536
v_cvt_pk_bf16_f32 v27, v133, v137
buffer_store_dwordx4 v[24:27], v149, s[32:35], s47 offen sc1
s_add_u32 s47, s47, 65536
v_cvt_pk_bf16_f32 v31, v134, v138
buffer_store_dwordx4 v[28:31], v149, s[32:35], s47 offen sc1
s_add_u32 s47, s47, 65536
v_cvt_pk_bf16_f32 v35, v135, v139
buffer_store_dwordx4 v[32:35], v149, s[32:35], s47 offen sc1
s_cmp_ge_u32 s57, 10
s_cbranch_scc1 L_fin
s_barrier
s_add_u32 s45, s45, 28160
s_add_u32 m0, s46, 4096
s_nop 0
buffer_load_dwordx4 v141, s[36:39], s45 offen  lds
s_add_u32 s45, s45, 10240
s_add_u32 m0, s46, 5120
s_nop 0
buffer_load_dwordx4 v141, s[36:39], s45 offen  lds
s_add_u32 s45, s45, 4294959616
s_add_u32 m0, s46, 6144
s_nop 0
buffer_load_dwordx4 v141, s[36:39], s45 offen  lds
s_add_u32 s45, s45, 10240
s_add_u32 m0, s46, 7168
s_nop 0
buffer_load_dwordx4 v141, s[36:39], s45 offen  lds
s_add_u32 s45, s45, 28160
s_add_u32 m0, s46, 8192
s_nop 0
buffer_load_dwordx4 v141, s[36:39], s45 offen  lds
s_add_u32 s45, s45, 10240
s_add_u32 m0, s46, 9216
s_nop 0
buffer_load_dwordx4 v141, s[36:39], s45 offen  lds
s_add_u32 s45, s45, 4294959616
s_add_u32 m0, s46, 10240
s_nop 0
buffer_load_dwordx4 v141, s[36:39], s45 offen  lds
s_add_u32 s45, s45, 10240
s_add_u32 m0, s46, 11264
s_nop 0
buffer_load_dwordx4 v141, s[36:39], s45 offen  lds
s_add_u32 s45, s45, 28160
s_add_u32 m0, s46, 12288
s_nop 0
buffer_load_dwordx4 v141, s[36:39], s45 offen  lds
s_add_u32 s45, s45, 10240
s_add_u32 m0, s46, 13312
s_nop 0
buffer_load_dwordx4 v141, s[36:39], s45 offen  lds
s_add_u32 s45, s45, 4294959616
s_add_u32 m0, s46, 14336
s_nop 0
buffer_load_dwordx4 v141, s[36:39], s45 offen  lds
s_add_u32 s45, s45, 10240
s_add_u32 m0, s46, 15360
s_nop 0
buffer_load_dwordx4 v141, s[36:39], s45 offen  lds
v_lshrrev_b32 v8, 2, v0
v_lshlrev_b32 v10, 7, v8
v_bfe_u32 v8, v8, 1, 2
v_lshl_add_u32 v10, v8, 5, v10
v_and_b32 v8, 3, v0
v_lshl_add_u32 v10, v8, 3, v10
v_add_u32 v10, s46, v10
v_xor_b32 v11, 32, v10
v_xor_b32 v12, 64, v10
v_xor_b32 v13, 0x60, v10
s_lshl_b32 s52, s44, 10
s_add_u32 s52, s52, 262144
s_add_u32 s47, s52, 32768
v_lshlrev_b32 v14, 8, v8
v_lshl_add_u32 v14, v2, 4, v14
v_lshrrev_b32 v8, 2, v1
v_lshl_add_u32 v14, v8, 6, v14
s_lshl_b32 s54, s31, 8
s_add_u32 s54, s54, 154112
v_lshl_add_u32 v15, v1, 2, s54
v_and_b32 v18, 31, v0
v_lshlrev_b32 v16, 3, v18
v_add_u32 v16, 154112, v16
s_mul_i32 s53, s56, 1280
s_lshl_b32 s54, s57, 7
s_add_u32 s53, s53, s54
s_add_u32 s53, s53, 606208
v_lshlrev_b32 v18, 2, v18
s_cmp_eq_u32 s56, 0
s_cselect_b32 s55, 0, 2147483632
v_max_u32 v9, s55, v18
buffer_load_dword v9, v9, s[48:51], s54 offen
v_and_b32 v18, 0x70, v18
v_lshrrev_b32 v8, 5, v0
v_and_b32 v19, 3, v0
v_lshl_add_u32 v8, v8, 2, v19
v_mul_u32_u24 v8, 10240, v8
v_add_u32 v18, v18, v8
s_waitcnt vmcnt(18)
ds_read_b64_tr_b16 a[0:1], v10 offset:0
ds_read_b64_tr_b16 a[2:3], v10 offset:2048
ds_read_b64_tr_b16 a[16:17], v11 offset:0
ds_read_b64_tr_b16 a[18:19], v11 offset:2048
ds_read_b64_tr_b16 a[32:33], v12 offset:0
ds_read_b64_tr_b16 a[34:35], v12 offset:2048
ds_read_b64_tr_b16 a[48:49], v13 offset:0
ds_read_b64_tr_b16 a[50:51], v13 offset:2048
s_waitcnt vmcnt(9)
ds_read_b64_tr_b16 a[4:5], v10 offset:4096
ds_read_b64_tr_b16 a[6:7], v10 offset:6144
ds_read_b64_tr_b16 a[20:21], v11 offset:4096
ds_read_b64_tr_b16 a[22:23], v11 offset:6144
ds_read_b64_tr_b16 a[36:37], v12 offset:4096
ds_read_b64_tr_b16 a[38:39], v12 offset:6144
ds_read_b64_tr_b16 a[52:53], v13 offset:4096
ds_read_b64_tr_b16 a[54:55], v13 offset:6144
s_waitcnt vmcnt(5)
ds_read_b64_tr_b16 a[8:9], v10 offset:8192
ds_read_b64_tr_b16 a[10:11], v10 offset:10240
ds_read_b64_tr_b16 a[24:25], v11 offset:8192
ds_read_b64_tr_b16 a[26:27], v11 offset:10240
ds_read_b64_tr_b16 a[40:41], v12 offset:8192
ds_read_b64_tr_b16 a[42:43], v12 offset:10240
ds_read_b64_tr_b16 a[56:57], v13 offset:8192
ds_read_b64_tr_b16 a[58:59], v13 offset:10240
s_mov_b32 s45, s52
buffer_load_dwordx4 v[20:23], v14, s[32:35], s45 offen sc1
s_waitcnt vmcnt(2)
ds_read_b64_tr_b16 a[12:13], v10 offset:12288
ds_read_b64_tr_b16 a[14:15], v10 offset:14336
ds_read_b64_tr_b16 a[28:29], v11 offset:12288
ds_read_b64_tr_b16 a[30:31], v11 offset:14336
ds_read_b64_tr_b16 a[44:45], v12 offset:12288
ds_read_b64_tr_b16 a[46:47], v12 offset:14336
ds_read_b64_tr_b16 a[60:61], v13 offset:12288
ds_read_b64_tr_b16 a[62:63], v13 offset:14336
s_waitcnt lgkmcnt(0)
s_branch L_epc
L_ep:
s_sub_u32 s60, s60, 1
s_and_b32 s45, s60, 31
s_cselect_b32 s45, s52, s47
buffer_load_dwordx4 v[20:23], v14, s[32:35], s45 offen sc1
s_cmp_eq_u32 s60, -1
s_cbranch_scc1 L_end
L_epc:
s_waitcnt vmcnt(0)
v_cmp_eq_u32 vcc, -1, v23
s_and_b64 exec, exec, vcc
s_cbranch_scc1 L_ep
s_mov_b64 exec, -1
v_mfma_f32_16x16x32_bf16 v[40:43], v[20:23], a[0:3], 0
v_mov_b32_dpp v24, v20 row_shl:4 row_mask:0xf bank_mask:0xf
v_mov_b32_dpp v25, v21 row_shl:4 row_mask:0xf bank_mask:0xf
v_mfma_f32_16x16x32_bf16 v[44:47], v[20:23], a[16:19], 0
v_mov_b32_dpp v26, v22 row_shl:4 row_mask:0xf bank_mask:0xf
v_mov_b32_dpp v27, v23 row_shl:4 row_mask:0xf bank_mask:0xf
v_mfma_f32_16x16x32_bf16 v[48:51], v[20:23], a[32:35], 0
v_mfma_f32_16x16x32_bf16 v[52:55], v[20:23], a[48:51], 0
v_mfma_f32_16x16x32_bf16 v[40:43], v[24:27], a[4:7], v[40:43]
v_mov_b32_dpp v28, v20 row_shl:8 row_mask:0xf bank_mask:0xf
v_mov_b32_dpp v29, v21 row_shl:8 row_mask:0xf bank_mask:0xf
v_mfma_f32_16x16x32_bf16 v[44:47], v[24:27], a[20:23], v[44:47]
v_mov_b32_dpp v30, v22 row_shl:8 row_mask:0xf bank_mask:0xf
v_mov_b32_dpp v31, v23 row_shl:8 row_mask:0xf bank_mask:0xf
v_mfma_f32_16x16x32_bf16 v[48:51], v[24:27], a[36:39], v[48:51]
v_mfma_f32_16x16x32_bf16 v[52:55], v[24:27], a[52:55], v[52:55]
v_mfma_f32_16x16x32_bf16 v[40:43], v[28:31], a[8:11], v[40:43]
v_mov_b32_dpp v32, v20 row_shl:12 row_mask:0xf bank_mask:0xf
v_mov_b32_dpp v33, v21 row_shl:12 row_mask:0xf bank_mask:0xf
v_mfma_f32_16x16x32_bf16 v[44:47], v[28:31], a[24:27], v[44:47]
v_mov_b32_dpp v34, v22 row_shl:12 row_mask:0xf bank_mask:0xf
v_mov_b32_dpp v35, v23 row_shl:12 row_mask:0xf bank_mask:0xf
v_mfma_f32_16x16x32_bf16 v[48:51], v[28:31], a[40:43], v[48:51]
v_mfma_f32_16x16x32_bf16 v[52:55], v[28:31], a[56:59], v[52:55]
v_mfma_f32_16x16x32_bf16 v[40:43], v[32:35], a[12:15], v[40:43]
v_mfma_f32_16x16x32_bf16 v[44:47], v[32:35], a[28:31], v[44:47]
v_mfma_f32_16x16x32_bf16 v[48:51], v[32:35], a[44:47], v[48:51]
v_mfma_f32_16x16x32_bf16 v[52:55], v[32:35], a[60:63], v[52:55]
s_mov_b64 exec, 0xffff
s_nop 3
v_pk_add_f32 v[40:41], v[40:41], v[42:43]
v_add_f32 v40, v40, v41
v_pk_add_f32 v[44:45], v[44:45], v[46:47]
v_add_f32 v44, v44, v45
ds_write2_b32 v15, v40, v44 offset0:0 offset1:16
v_pk_add_f32 v[48:49], v[48:49], v[50:51]
v_add_f32 v48, v48, v49
v_pk_add_f32 v[52:53], v[52:53], v[54:55]
v_add_f32 v52, v52, v53
ds_write2_b32 v15, v48, v52 offset0:32 offset1:48
s_mov_b64 exec, -1
s_waitcnt lgkmcnt(0)
s_barrier
s_cmp_lg_u32 s31, 0
s_cbranch_scc1 L_end
ds_read_b64 v[60:61], v16
ds_read_b64 v[62:63], v16 offset:256
ds_read_b64 v[64:65], v16 offset:512
ds_read_b64 v[66:67], v16 offset:768
v_lshlrev_b32 v8, 16, v9
v_and_b32 v9, 0xffff0000, v9
s_waitcnt lgkmcnt(2)
v_pk_add_f32 v[60:61], v[60:61], v[62:63]
v_pk_add_f32 v[60:61], v[60:61], v[8:9]
s_waitcnt lgkmcnt(0)
v_pk_add_f32 v[64:65], v[64:65], v[66:67]
v_pk_add_f32 v[60:61], v[60:61], v[64:65]
v_cvt_pk_bf16_f32 v64, v60, v61
s_nop 1
v_mov_b32_dpp v60, v64 quad_perm:[0,0,0,0] row_mask:0xf bank_mask:0xf
v_mov_b32_dpp v61, v64 quad_perm:[1,1,1,1] row_mask:0xf bank_mask:0xf
v_mov_b32_dpp v62, v64 quad_perm:[2,2,2,2] row_mask:0xf bank_mask:0xf
v_mov_b32_dpp v63, v64 quad_perm:[3,3,3,3] row_mask:0xf bank_mask:0xf
buffer_store_dwordx4 v[60:63], v18, s[32:35], s53 offen sc1
s_mov_b64 exec, -1
s_branch L_end
L_fin:
s_sub_u32 s52, s57, 10
s_mul_i32 s54, s44, 163840
s_lshl_b32 s55, s52, 13
s_add_u32 s54, s54, s55
s_add_u32 s54, s54, 114688
v_lshlrev_b32 v250, 7, v0
s_barrier
buffer_load_dword v251, v250, s[36:39], s54 offen
s_mov_b32 s40, s22
s_mov_b32 s41, s23
s_mov_b32 s42, 2211840
s_mov_b32 s43, 0x20000
s_lshl_b32 s55, s52, 2
s_add_u32 s55, s55, s31
s_lshl_b32 s53, s55, 13
s_mul_i32 s54, s56, 327680
s_add_u32 s54, s54, s53
v_add_u32 v250, s54, v250
v_add_u32 v249, 196608, v250
buffer_load_dword v253, v250, s[40:43], 0 offen
s_cmp_ge_u32 s55, 16
s_cbranch_scc1 L_hd
buffer_load_dword v254, v249, s[40:43], 0 offen
L_hd:
s_lshl_b32 s52, s52, 3
s_add_u32 s52, s52, s56
s_cmp_ge_u32 s52, 20
s_cbranch_scc1 L_end
s_lshl_b32 s53, s52, 6
v_lshrrev_b32 v8, 3, v0
v_and_b32 v9, 7, v0
v_mul_u32_u24 v10, 1280, v8
v_lshl_add_u32 v10, v9, 3, v10
v_lshlrev_b32 v11, 1, v10
v_mov_b32 v19, 2147483632
v_cmp_gt_u32 vcc, 24, v0
s_nop 1
v_cndmask_b32 v19, v19, v11, vcc
s_mul_i32 s54, s56, 10240
s_add_u32 s54, s54, s53
s_add_u32 s54, s54, 606208
s_mul_i32 s55, s31, 69120
s_lshl_b32 s44, s52, 7
s_add_u32 s44, s44, s55
s_add_u32 s44, s44, 327680
s_add_u32 s45, s44, 20480
s_add_u32 s46, s44, 40960
s_add_u32 s47, s44, 61440
v_lshl_add_u32 v16, v9, 2, v2
v_lshlrev_b32 v16, 4, v16
s_lshl_b32 s55, s31, 2
s_add_u32 s55, s55, 154112
v_add_u32 v16, s55, v16
v_add_u32 v18, 154112, v17
v_lshlrev_b32 v2, 1, v0
v_mov_b32 v3, 0
s_cmp_eq_u32 s31, 0
s_cselect_b32 s55, -1, 0
s_mov_b32 s36, s24
s_mov_b32 s37, s25
s_mov_b32 s38, 1280
s_mov_b32 s39, 0x20000
L_fp:
buffer_load_dwordx2 v[8:9], v10, s[32:35], s54 offen sc1
s_sub_u32 s60, s60, 1
s_cbranch_scc1 L_end
L_fpc:
s_waitcnt vmcnt(0)
v_max_u32 v36, v8, v9
v_cmp_eq_u32 vcc, -1, v36
s_and_b64 exec, exec, vcc
s_cbranch_scc1 L_fp
s_mov_b64 exec, -1
v_and_b32 v8, s55, v8
v_and_b32 v9, s55, v9
v_lshlrev_b32 v12, 16, v8
v_and_b32 v13, 0xffff0000, v8
v_lshlrev_b32 v14, 16, v9
v_and_b32 v15, 0xffff0000, v9
L_fq:
buffer_load_dwordx4 v[40:43], v11, s[32:35], s44 offen sc1
buffer_load_dwordx4 v[44:47], v11, s[32:35], s45 offen sc1
buffer_load_dwordx4 v[48:51], v11, s[32:35], s46 offen sc1
buffer_load_dwordx4 v[52:55], v19, s[32:35], s47 offen sc1
s_sub_u32 s60, s60, 1
s_cbranch_scc1 L_end
L_fqc:
s_waitcnt vmcnt(0)
v_max3_u32 v36, v43, v47, v51
v_max_u32 v36, v36, v55
v_cmp_eq_u32 vcc, -1, v36
s_and_b64 exec, exec, vcc
s_cbranch_scc1 L_fq
s_mov_b64 exec, -1
v_pk_add_f32 v[20:21], v[40:41], v[44:45]
v_pk_add_f32 v[22:23], v[42:43], v[46:47]
v_pk_add_f32 v[28:29], v[48:49], v[52:53]
v_pk_add_f32 v[30:31], v[50:51], v[54:55]
v_pk_add_f32 v[20:21], v[20:21], v[12:13]
v_pk_add_f32 v[22:23], v[22:23], v[14:15]
v_pk_add_f32 v[20:21], v[20:21], v[28:29]
v_pk_add_f32 v[22:23], v[22:23], v[30:31]
s_nop 1
v_permlane32_swap_b32 v20, v22
v_permlane32_swap_b32 v21, v23
v_pk_add_f32 v[20:21], v[20:21], v[22:23]
s_nop 1
v_permlane16_swap_b32 v20, v21
v_add_f32 v20, v20, v21
s_nop 1
v_add_f32_dpp v20, v20, v20 row_ror:8 row_mask:0xf bank_mask:0xf
ds_write_b32 v16, v20
s_waitcnt lgkmcnt(0)
s_barrier
s_cmp_lg_u32 s31, 0
s_cbranch_scc1 L_end
s_mov_b32 exec_hi, 0
ds_read_b128 v[20:23], v18
s_waitcnt lgkmcnt(0)
v_pk_add_f32 v[20:21], v[20:21], v[22:23]
v_add_f32 v20, v20, v21
v_cvt_pk_bf16_f32 v20, v20, v20
buffer_store_short v20, v2, s[36:39], s53 offen
s_cmp_lg_u32 s52, 0
s_cbranch_scc1 L_nw
s_mov_b64 exec, 1
v_mov_b32 v21, s30
buffer_store_dword v21, v3, s[32:35], 0 offen sc1
L_nw:
s_mov_b64 exec, -1
s_branch L_end
L_S2:
s_lshl_b32 s52, s3, 14
s_lshl_b32 s53, s31, 12
s_add_u32 s58, s52, s53
s_add_u32 s58, s58, 1048576
s_mul_i32 s53, s3, 3072
s_lshl_b32 s54, s31, 10
s_add_u32 s53, s53, s54
s_add_u32 s53, s53, 196608
s_lshl_b32 s54, s3, 8
s_add_u32 s54, s54, 131072
s_cmp_eq_u32 s31, 3
s_cselect_b32 s53, s54, s53
s_cselect_b32 s54, 16, 64
s_lshl_b32 s55, s3, 9
s_add_u32 s55, s55, 458496
v_add_u32 v3, s55, v17
v_cmp_gt_u32 vcc, s54, v0
s_nop 1
v_cndmask_b32 v3, v3, v17, vcc
v_mov_b32 v8, -1
v_mov_b32 v9, -1
v_mov_b32 v10, -1
v_mov_b32 v11, -1
v_and_b32 v19, 3, v1
v_xor_b32 v20, v1, v2
v_lshlrev_b32 v20, 4, v20
v_lshl_add_u32 v20, v2, 13, v20
v_xor_b32 v21, 64, v20
v_xor_b32 v22, 0x80, v20
v_xor_b32 v23, 0xc0, v20
s_lshl_b32 s61, s31, 13
s_mov_b32 m0, s61
s_lshl_b32 s54, s57, 7
s_lshl_b32 s55, s31, 5
s_add_u32 s54, s54, s55
s_lshl_b32 s54, s54, 13
s_lshl_b32 s55, s56, 8
s_add_u32 s54, s54, s55
s_waitcnt lgkmcnt(0)
s_load_dword s30, s[28:29], 0
s_mov_b32 s32, s28
s_mov_b32 s33, s29
s_mov_b32 s34, 268435456
s_mov_b32 s35, 0x20000
s_mov_b32 s36, s10
s_mov_b32 s37, s11
s_mov_b32 s38, 4194304
s_mov_b32 s39, 0x20000
s_getpc_b64 s[26:27]
L_pc:
s_sub_u32 s26, s26, L_pc-sequential_preLN__compressed_kv_cla__glu_gated_geglu__decode_kernel
s_subb_u32 s27, s27, 0
s_lshl_b32 s55, s31, 13
v_lshlrev_b32 v12, 7, v0
v_add_u32 v12, s55, v12
v_min_u32 v12, L_exit-sequential_preLN__compressed_kv_cla__glu_gated_geglu__decode_kernel, v12
global_load_dword v13, v12, s[26:27]
buffer_store_dwordx4 v[8:11], v3, s[32:35], s53 offen sc1
s_mov_b32 s50, s54
buffer_load_dwordx4 v20, s[36:39], s50 offen  lds
s_add_u32 s50, s50, 32768
s_add_u32 m0, m0, 1024
s_nop 0
buffer_load_dwordx4 v20, s[36:39], s50 offen  lds
s_add_u32 s50, s50, 32768
s_add_u32 m0, m0, 1024
s_nop 0
buffer_load_dwordx4 v21, s[36:39], s50 offen  lds
s_add_u32 s50, s50, 32768
s_add_u32 m0, m0, 1024
s_nop 0
buffer_load_dwordx4 v21, s[36:39], s50 offen  lds
s_add_u32 s50, s50, 32768
s_add_u32 m0, m0, 1024
s_nop 0
buffer_load_dwordx4 v22, s[36:39], s50 offen  lds
s_add_u32 s50, s50, 32768
s_add_u32 m0, m0, 1024
s_nop 0
buffer_load_dwordx4 v22, s[36:39], s50 offen  lds
s_add_u32 s50, s50, 32768
s_add_u32 m0, m0, 1024
v_mov_b32 v100, 0x3f803f80
v_mov_b32 v101, 0x3f803f80
v_mov_b32 v102, 0x3f803f80
v_mov_b32 v103, 0x3f803f80
v_lshlrev_b32 v14, 4, v2
v_lshrrev_b32 v12, 2, v1
v_lshlrev_b32 v12, 11, v12
v_lshl_add_u32 v12, v19, 8, v12
v_and_b32 v15, 0xf0, v20
v_add3_u32 v64, v12, v15, s61
v_xor_b32 v65, 64, v64
v_xor_b32 v66, 0x80, v64
v_xor_b32 v67, 0xc0, v64
s_mul_i32 s61, s31, 320
v_mov_b32 v12, 0
v_lshlrev_b32 v16, 3, v0
v_and_b32 v3, 0xf8, v16
v_lshrrev_b32 v15, 5, v0
v_lshl_add_u32 v15, v15, 2, v3
v_add_u32 v15, 98304, v15
v_add_u32 v16, 98304, v14
s_lshl_b32 s52, s56, 11
s_add_u32 s52, s52, 65536
s_add_u32 s49, s52, 720896
s_mov_b32 s54, 0x0c0c0400
s_mov_b32 s55, 0x05040100
s_waitcnt lgkmcnt(0)
s_mul_i32 s30, s30, 0x9E3779B5
s_add_u32 s30, s30, 0x7F4A7C15
s_waitcnt vmcnt(6)
buffer_load_dwordx4 v23, s[36:39], s50 offen  lds
s_add_u32 s50, s50, 32768
s_add_u32 m0, m0, 1024
s_nop 0
buffer_load_dwordx4 v23, s[36:39], s50 offen  lds
s_barrier
s_cmp_lg_u32 s31, 0
s_cbranch_scc1 L_nofl
s_lshl_b32 s53, s3, 7
s_add_u32 s53, s53, 163840
v_mov_b32 v24, s30
s_mov_b64 exec, 1
buffer_store_dword v24, v12, s[32:35], s53 offen sc1
s_mov_b64 exec, -1
L_nofl:
s_lshl_b32 s59, s3, 2
s_add_u32 s59, s59, s31
s_lshl_b32 s53, s59, 6
s_add_u32 s53, s53, 131072
s_mov_b32 s40, s6
s_mov_b32 s41, s7
s_mov_b32 s42, 8388608
s_mov_b32 s43, 0x20000
s_cmp_lt_u32 s31, 2
s_cbranch_scc1 L_npf
s_lshr_b32 s44, s3, 1
s_lshl_b32 s44, s44, 7
s_and_b32 s45, s31, 1
s_lshl_b32 s45, s45, 6
s_add_u32 s44, s44, s45
s_and_b32 s45, s3, 1
s_lshl_b32 s45, s45, 4
s_add_u32 s44, s44, s45
s_add_u32 s44, s44, 12
s_lshl_b32 s44, s44, 10
s_add_u32 s45, s44, 32768
v_lshlrev_b32 v252, 7, v0
s_bfm_b64 exec, 32, 0
buffer_load_dword v253, v252, s[40:43], s44 offen
buffer_load_dword v254, v252, s[40:43], s45 offen
s_mov_b64 exec, -1
s_branch L_npf2
L_npf:
L_npf2:
s_waitcnt vmcnt(2)
s_cmp_ge_u32 s31, 2
s_cbranch_scc1 L_w0
s_waitcnt vmcnt(1)
s_cmp_eq_u32 s31, 0
s_cbranch_scc1 L_w0
s_waitcnt vmcnt(0)
L_w0:
ds_read_b128 v[20:23], v64 offset:0
ds_read_b128 v[24:27], v65 offset:0
ds_read_b128 v[28:31], v66 offset:0
ds_read_b128 v[32:35], v67 offset:0
ds_read_b128 v[36:39], v64 offset:1024
ds_read_b128 v[40:43], v65 offset:1024
ds_read_b128 v[44:47], v66 offset:1024
ds_read_b128 v[48:51], v67 offset:1024
s_cmp_lg_u32 s31, 1
s_cbranch_scc1 L_qb
L_h1:
s_sub_u32 s60, s60, 1
s_and_b32 s48, s60, 31
s_cselect_b32 s48, s52, s49
buffer_load_dwordx4 v[52:55], v17, s[32:35], s48 offen sc1
buffer_load_dwordx4 v[56:59], v17, s[32:35], s48 offen offset:1024 sc1
s_cmp_eq_u32 s60, -1
s_cbranch_scc1 L_end
s_waitcnt vmcnt(0)
v_perm_b32 v60, v53, v52, s54
v_perm_b32 v61, v55, v54, s54
v_perm_b32 v62, v57, v56, s54
v_perm_b32 v63, v59, v58, s54
v_perm_b32 v60, v61, v60, s55
v_perm_b32 v62, v63, v62, s55
v_cmp_ne_u32 vcc, s30, v60
v_cmp_ne_u32 s[16:17], s30, v62
s_or_b64 vcc, vcc, s[16:17]
s_cbranch_vccnz L_h1
v_pk_add_f32 v[52:53], v[52:53], v[56:57]
v_pk_add_f32 v[54:55], v[54:55], v[58:59]
s_nop 1
v_permlane32_swap_b32 v52, v54
v_permlane32_swap_b32 v53, v55
v_pk_add_f32 v[52:53], v[52:53], v[54:55]
v_mul_f32 v52, 0x3e0293ee, v52
v_mul_f32 v53, 0x3e0293ee, v53
v_cvt_pk_bf16_f32 v52, v52, v53
ds_write_b32 v15, v52
s_waitcnt lgkmcnt(0)
L_qb:
s_barrier
ds_read_b128 v[60:63], v16 offset:0
ds_read_b128 v[64:67], v16 offset:64
ds_read_b128 v[68:71], v16 offset:128
ds_read_b128 v[72:75], v16 offset:192
s_waitcnt lgkmcnt(3)
v_mfma_f32_16x16x32_bf16 v[76:79], v[20:23], v[60:63], 0
v_mfma_f32_16x16x32_bf16 v[80:83], v[36:39], v[60:63], 0
s_waitcnt lgkmcnt(2)
v_mfma_f32_16x16x32_bf16 v[76:79], v[24:27], v[64:67], v[76:79]
v_mfma_f32_16x16x32_bf16 v[80:83], v[40:43], v[64:67], v[80:83]
s_waitcnt lgkmcnt(1)
v_mfma_f32_16x16x32_bf16 v[76:79], v[28:31], v[68:71], v[76:79]
v_mfma_f32_16x16x32_bf16 v[80:83], v[44:47], v[68:71], v[80:83]
s_waitcnt lgkmcnt(0)
v_mfma_f32_16x16x32_bf16 v[76:79], v[32:35], v[72:75], v[76:79]
v_mfma_f32_16x16x32_bf16 v[80:83], v[48:51], v[72:75], v[80:83]
s_mov_b32 exec_lo, 0x00010001
s_mov_b32 exec_hi, 0x00010001
s_nop 4
v_cvt_pk_bf16_f32 v52, v76, v77
v_cvt_pk_bf16_f32 v53, v78, v79
v_cvt_pk_bf16_f32 v54, v80, v81
v_cvt_pk_bf16_f32 v55, v82, v83
buffer_store_dwordx4 v[52:55], v14, s[32:35], s53 offen sc1
s_mov_b64 exec, -1
s_mov_b32 s36, s12
s_mov_b32 s37, s13
s_mov_b32 s38, 4194304
s_mov_b32 s39, 0x20000
v_lshrrev_b32 v8, 3, v0
v_and_b32 v9, 3, v8
v_lshrrev_b32 v10, 2, v8
v_lshl_add_u32 v9, v9, 3, v10
v_lshlrev_b32 v9, 13, v9
v_and_b32 v10, 6, v8
v_and_b32 v8, 7, v0
v_xor_b32 v8, v8, v10
v_lshl_add_u32 v9, v8, 4, v9
s_and_b32 s52, s31, 1
s_lshl_b32 s52, s52, 6
s_lshl_b32 s53, s57, 7
s_add_u32 s52, s52, s53
s_lshl_b32 s52, s52, 13
s_lshl_b32 s53, s56, 8
s_add_u32 s52, s52, s53
s_lshr_b32 s53, s31, 1
s_lshl_b32 s54, s53, 7
s_add_u32 s52, s52, s54
s_lshl_b32 s54, s31, 13
s_mov_b32 m0, s54
s_mov_b32 s27, s54
s_barrier
v_and_b32 v113, 31, v0
v_lshlrev_b32 v113, 7, v113
s_mov_b32 s55, 163840
buffer_load_dword v109, v113, s[32:35], s55 offen sc1
s_add_u32 m0, s27, 0
s_nop 0
buffer_load_dwordx4 v9, s[36:39], s52 offen  lds
s_add_u32 s52, s52, 16384
s_add_u32 m0, s27, 1024
s_nop 0
buffer_load_dwordx4 v9, s[36:39], s52 offen  lds
s_add_u32 s52, s52, 245760
s_add_u32 m0, s27, 2048
s_nop 0
buffer_load_dwordx4 v9, s[36:39], s52 offen  lds
s_add_u32 s52, s52, 16384
s_add_u32 m0, s27, 3072
s_nop 0
buffer_load_dwordx4 v9, s[36:39], s52 offen  lds
s_add_u32 s52, s52, 4294721536
s_add_u32 m0, s27, 4096
s_nop 0
buffer_load_dwordx4 v9, s[36:39], s52 offen  lds
s_add_u32 s52, s52, 16384
s_add_u32 m0, s27, 5120
s_nop 0
buffer_load_dwordx4 v9, s[36:39], s52 offen  lds
s_add_u32 s52, s52, 245760
s_add_u32 m0, s27, 6144
s_nop 0
buffer_load_dwordx4 v9, s[36:39], s52 offen  lds
s_add_u32 s52, s52, 16384
s_add_u32 m0, s27, 7168
s_nop 0
buffer_load_dwordx4 v9, s[36:39], s52 offen  lds
s_mov_b32 s36, s18
s_mov_b32 s37, s19
s_mov_b32 s38, 2211840
s_mov_b32 s39, 0x20000
s_mov_b32 s40, s20
s_mov_b32 s41, s21
s_mov_b32 s42, 2211840
s_mov_b32 s43, 0x20000
s_mov_b32 s44, s22
s_mov_b32 s45, s23
s_mov_b32 s46, 2211840
s_mov_b32 s47, 0x20000
v_bfe_u32 v8, v0, 3, 2
v_lshlrev_b32 v8, 3, v8
v_lshrrev_b32 v10, 5, v0
v_lshl_add_u32 v8, v10, 2, v8
v_bfe_u32 v10, v0, 1, 2
v_add_u32 v8, v8, v10
v_mul_u32_u24 v8, 3456, v8
v_and_b32 v10, 1, v0
v_lshl_add_u32 v104, v10, 4, v8
s_mul_i32 s48, s31, 552960
s_lshl_b32 s54, s3, 5
s_add_u32 s48, s48, s54
s_and_b32 s51, s31, 1
s_and_b32 s26, s3, 3
s_mul_i32 s54, s31, 10240
s_add_u32 s54, s54, 32768
v_lshrrev_b32 v10, 2, v0
s_cmp_lt_u32 s3, 108
s_cbranch_scc1 L_fg
s_waitcnt vmcnt(0)
s_branch L_nofg
L_fg:
s_lshl_b32 s49, s26, 11
s_add_u32 m0, s54, s49
s_add_u32 s49, s26, s51
s_cmp_eq_u32 s49, 5
s_cselect_b32 s49, 0, s49
s_mul_i32 s49, s49, 110592
s_add_u32 s49, s49, s48
buffer_load_dwordx4 v104, s[36:39], s49 offen  lds
s_add_u32 m0, m0, 1024
s_add_u32 s26, s26, 1
buffer_load_dwordx4 v104, s[40:43], s49 offen  lds
s_cmp_eq_u32 s26, 5
s_cselect_b32 s26, 0, s26
s_lshl_b32 s49, s26, 11
s_add_u32 m0, s54, s49
s_add_u32 s49, s26, s51
s_cmp_eq_u32 s49, 5
s_cselect_b32 s49, 0, s49
s_mul_i32 s49, s49, 110592
s_add_u32 s49, s49, s48
buffer_load_dwordx4 v104, s[36:39], s49 offen  lds
s_add_u32 m0, m0, 1024
s_add_u32 s26, s26, 1
buffer_load_dwordx4 v104, s[40:43], s49 offen  lds
s_cmp_eq_u32 s26, 5
s_cselect_b32 s26, 0, s26
s_lshl_b32 s49, s26, 11
s_add_u32 m0, s54, s49
s_add_u32 s49, s26, s51
s_cmp_eq_u32 s49, 5
s_cselect_b32 s49, 0, s49
s_mul_i32 s49, s49, 110592
s_add_u32 s49, s49, s48
buffer_load_dwordx4 v104, s[36:39], s49 offen  lds
s_add_u32 m0, m0, 1024
s_add_u32 s26, s26, 1
buffer_load_dwordx4 v104, s[40:43], s49 offen  lds
s_cmp_eq_u32 s26, 5
s_cselect_b32 s26, 0, s26
s_lshl_b32 s49, s26, 11
s_add_u32 m0, s54, s49
s_add_u32 s49, s26, s51
s_cmp_eq_u32 s49, 5
s_cselect_b32 s49, 0, s49
s_mul_i32 s49, s49, 110592
s_add_u32 s49, s49, s48
buffer_load_dwordx4 v104, s[36:39], s49 offen  lds
s_add_u32 m0, m0, 1024
s_add_u32 s26, s26, 1
buffer_load_dwordx4 v104, s[40:43], s49 offen  lds
s_cmp_eq_u32 s26, 5
s_cselect_b32 s26, 0, s26
s_lshl_b32 s49, s26, 11
s_add_u32 m0, s54, s49
s_add_u32 s49, s26, s51
s_cmp_eq_u32 s49, 5
s_cselect_b32 s49, 0, s49
s_mul_i32 s49, s49, 110592
s_add_u32 s49, s49, s48
buffer_load_dwordx4 v104, s[36:39], s49 offen  lds
s_add_u32 m0, m0, 1024
s_add_u32 s26, s26, 1
buffer_load_dwordx4 v104, s[40:43], s49 offen  lds
s_cmp_eq_u32 s26, 5
s_cselect_b32 s26, 0, s26
L_nofg:
v_lshlrev_b32 v11, 7, v10
v_bfe_u32 v8, v10, 1, 2
v_lshl_add_u32 v11, v8, 5, v11
v_lshl_add_u32 v11, v19, 3, v11
s_lshl_b32 s53, s53, 14
s_and_b32 s52, s31, 1
s_lshl_b32 s52, s52, 6
s_add_u32 s53, s53, s52
v_xor_b32 v11, s53, v11
v_xor_b32 v12, 32, v11
v_lshl_add_u32 v105, v0, 3, s54
v_mul_u32_u24 v106, 1280, v10
v_lshl_add_u32 v106, v19, 3, v106
s_add_u32 s55, s61, 73728
v_add_u32 v106, s55, v106
v_lshl_add_u32 v8, v19, 2, v2
v_lshlrev_b32 v8, 10, v8
s_lshl_b32 s52, s31, 14
s_lshr_b32 s53, s56, 4
s_lshl_b32 s53, s53, 9
s_add_u32 s52, s52, s53
s_and_b32 s53, s56, 15
s_lshl_b32 s53, s53, 3
s_add_u32 s52, s52, s53
s_bfe_u32 s53, s56, 0x20002
s_mul_i32 s53, s53, 96
s_add_u32 s52, s52, s53
s_add_u32 s52, s52, 196608
s_lshl_b32 s53, s31, 2
s_add_u32 s53, s53, 102400
v_mov_b32 v107, s53
v_mov_b32 v108, 102400
s_lshl_b32 s53, s31, 8
s_add_u32 s53, s53, 99328
v_lshlrev_b32 v15, 4, v1
v_lshl_add_u32 v15, v2, 3, v15
v_add_u32 v15, s53, v15
v_lshl_add_u32 v16, v19, 8, v14
v_add_u32 v16, 99328, v16
s_mov_b32 s55, 163840
s_waitcnt vmcnt(18)
s_branch L_f2c
L_f2:
buffer_load_dword v109, v113, s[32:35], s55 offen sc1
s_sub_u32 s60, s60, 1
s_cbranch_scc1 L_end
s_waitcnt vmcnt(0)
L_f2c:
v_cmp_ne_u32 vcc, s30, v109
s_cbranch_vccnz L_f2
buffer_load_dwordx2 v[110:111], v8, s[32:35], s52 offen sc1
s_waitcnt vmcnt(11)
s_barrier
ds_read_b64_tr_b16 a[0:1], v11 offset:0
ds_read_b64_tr_b16 a[2:3], v11 offset:2048
ds_read_b64_tr_b16 a[4:5], v11 offset:4096
ds_read_b64_tr_b16 a[6:7], v11 offset:6144
ds_read_b64_tr_b16 a[8:9], v11 offset:8192
ds_read_b64_tr_b16 a[10:11], v11 offset:10240
ds_read_b64_tr_b16 a[12:13], v11 offset:12288
ds_read_b64_tr_b16 a[14:15], v11 offset:14336
ds_read_b64_tr_b16 a[16:17], v12 offset:0
ds_read_b64_tr_b16 a[18:19], v12 offset:2048
ds_read_b64_tr_b16 a[20:21], v12 offset:4096
ds_read_b64_tr_b16 a[22:23], v12 offset:6144
ds_read_b64_tr_b16 a[24:25], v12 offset:8192
ds_read_b64_tr_b16 a[26:27], v12 offset:10240
ds_read_b64_tr_b16 a[28:29], v12 offset:12288
ds_read_b64_tr_b16 a[30:31], v12 offset:14336
s_branch L_mlc
L_ml:
buffer_load_dwordx2 v[110:111], v8, s[32:35], s52 offen sc1
s_sub_u32 s60, s60, 1
s_cbranch_scc1 L_end
L_mlc:
s_waitcnt vmcnt(0)
v_max_u32 v3, v110, v111
v_cmp_eq_u32 vcc, -1, v3
s_and_b64 exec, exec, vcc
s_cbranch_scc1 L_ml
s_mov_b64 exec, -1
buffer_load_dwordx4 v[112:115], v17, s[32:35], s58 offen offset:0 sc1
buffer_load_dwordx4 v[116:119], v17, s[32:35], s58 offen offset:1024 sc1
buffer_load_dwordx4 v[120:123], v17, s[32:35], s58 offen offset:2048 sc1
buffer_load_dwordx4 v[124:127], v17, s[32:35], s58 offen offset:3072 sc1
v_max_f32_dpp v12, v110, v110 quad_perm:[1,0,3,2] row_mask:0xf bank_mask:0xf
s_nop 1
v_max_f32_dpp v12, v12, v12 quad_perm:[2,3,0,1] row_mask:0xf bank_mask:0xf
v_mov_b32 v13, v12
s_nop 1
v_permlane16_swap_b32 v13, v12
v_max_f32 v12, v13, v12
v_mov_b32 v13, v12
s_nop 1
v_permlane32_swap_b32 v13, v12
v_max_f32 v12, v13, v12
v_sub_f32 v10, v110, v12
v_exp_f32 v10, v10
s_nop 0
v_cvt_pk_bf16_f32 v10, v10, v10
v_lshlrev_b32 v18, 16, v10
s_nop 0
v_and_b32_dpp v60, v10, v4 row_newbcast:0 row_mask:0xf bank_mask:0xf
v_and_b32_dpp v61, v10, v5 row_newbcast:0 row_mask:0xf bank_mask:0xf
v_and_b32_dpp v62, v10, v6 row_newbcast:0 row_mask:0xf bank_mask:0xf
v_and_b32_dpp v63, v10, v7 row_newbcast:0 row_mask:0xf bank_mask:0xf
v_and_b32_dpp v64, v10, v4 row_newbcast:1 row_mask:0xf bank_mask:0xf
v_and_b32_dpp v65, v10, v5 row_newbcast:1 row_mask:0xf bank_mask:0xf
v_and_b32_dpp v66, v10, v6 row_newbcast:1 row_mask:0xf bank_mask:0xf
v_and_b32_dpp v67, v10, v7 row_newbcast:1 row_mask:0xf bank_mask:0xf
v_and_b32_dpp v68, v10, v4 row_newbcast:2 row_mask:0xf bank_mask:0xf
v_and_b32_dpp v69, v10, v5 row_newbcast:2 row_mask:0xf bank_mask:0xf
v_and_b32_dpp v70, v10, v6 row_newbcast:2 row_mask:0xf bank_mask:0xf
v_and_b32_dpp v71, v10, v7 row_newbcast:2 row_mask:0xf bank_mask:0xf
v_and_b32_dpp v72, v10, v4 row_newbcast:3 row_mask:0xf bank_mask:0xf
v_and_b32_dpp v73, v10, v5 row_newbcast:3 row_mask:0xf bank_mask:0xf
v_and_b32_dpp v74, v10, v6 row_newbcast:3 row_mask:0xf bank_mask:0xf
v_and_b32_dpp v75, v10, v7 row_newbcast:3 row_mask:0xf bank_mask:0xf
v_mul_f32 v11, v111, v18
s_nop 1
v_add_f32_dpp v11, v11, v11 quad_perm:[1,0,3,2] row_mask:0xf bank_mask:0xf
s_nop 1
v_add_f32_dpp v11, v11, v11 quad_perm:[2,3,0,1] row_mask:0xf bank_mask:0xf
v_mov_b32 v13, v11
s_nop 1
v_permlane16_swap_b32 v13, v11
v_add_f32 v11, v13, v11
v_mov_b32 v13, v11
s_nop 1
v_permlane32_swap_b32 v13, v11
v_add_f32 v11, v13, v11
ds_write2_b32 v107, v12, v11 offset0:0 offset1:4
ds_read_b64_tr_b16 a[32:33], v105 offset:0
ds_read_b64_tr_b16 a[34:35], v105 offset:512
ds_read_b64_tr_b16 a[52:53], v105 offset:1024
ds_read_b64_tr_b16 a[54:55], v105 offset:1536
ds_read_b64_tr_b16 a[36:37], v105 offset:2048
ds_read_b64_tr_b16 a[38:39], v105 offset:2560
ds_read_b64_tr_b16 a[56:57], v105 offset:3072
ds_read_b64_tr_b16 a[58:59], v105 offset:3584
ds_read_b64_tr_b16 a[40:41], v105 offset:4096
ds_read_b64_tr_b16 a[42:43], v105 offset:4608
ds_read_b64_tr_b16 a[60:61], v105 offset:5120
ds_read_b64_tr_b16 a[62:63], v105 offset:5632
ds_read_b64_tr_b16 a[44:45], v105 offset:6144
ds_read_b64_tr_b16 a[46:47], v105 offset:6656
ds_read_b64_tr_b16 a[64:65], v105 offset:7168
ds_read_b64_tr_b16 a[66:67], v105 offset:7680
ds_read_b64_tr_b16 a[48:49], v105 offset:8192
ds_read_b64_tr_b16 a[50:51], v105 offset:8704
ds_read_b64_tr_b16 a[68:69], v105 offset:9216
ds_read_b64_tr_b16 a[70:71], v105 offset:9728
s_branch L_h3c
L_h3:
buffer_load_dwordx4 v[112:115], v17, s[32:35], s58 offen offset:0 sc1
buffer_load_dwordx4 v[116:119], v17, s[32:35], s58 offen offset:1024 sc1
buffer_load_dwordx4 v[120:123], v17, s[32:35], s58 offen offset:2048 sc1
buffer_load_dwordx4 v[124:127], v17, s[32:35], s58 offen offset:3072 sc1
s_sub_u32 s60, s60, 1
s_cbranch_scc1 L_end
L_h3c:
s_waitcnt vmcnt(0)
v_max3_u32 v3, v115, v119, v123
v_max_u32 v3, v3, v127
v_cmp_eq_u32 vcc, -1, v3
s_and_b64 exec, exec, vcc
s_cbranch_scc1 L_h3
s_mov_b64 exec, -1
v_mfma_f32_16x16x32_bf16 v[76:79], v[60:63], v[112:115], 0
v_mfma_f32_16x16x32_bf16 v[76:79], v[64:67], v[116:119], v[76:79]
v_mfma_f32_16x16x32_bf16 v[76:79], v[68:71], v[120:123], v[76:79]
v_mfma_f32_16x16x32_bf16 v[76:79], v[72:75], v[124:127], v[76:79]
s_mov_b32 exec_hi, 0
s_lshl_b32 s53, s59, 6
s_add_u32 s53, s53, 262144
s_add_u32 s55, s53, 32768
v_lshlrev_b32 v13, 2, v0
s_nop 2
v_cvt_pk_bf16_f32 v76, v76, v77
v_cvt_pk_bf16_f32 v77, v78, v79
ds_write_b64 v15, v[76:77]
s_mov_b64 exec, -1
s_waitcnt lgkmcnt(0)
s_barrier
ds_read_b128 v[20:23], v16
ds_read_b128 v[36:39], v108
ds_read_b128 v[40:43], v108 offset:16
ds_read_b128 v[24:27], v16 offset:64
ds_read_b128 v[28:31], v16 offset:128
ds_read_b128 v[32:35], v16 offset:192
s_waitcnt lgkmcnt(5)
v_mfma_f32_16x16x32_bf16 v[76:79], v[20:23], a[0:3], 0
v_mfma_f32_16x16x32_bf16 v[80:83], v[20:23], a[16:19], 0
s_waitcnt lgkmcnt(2)
v_mfma_f32_16x16x32_bf16 v[76:79], v[24:27], a[4:7], v[76:79]
v_mfma_f32_16x16x32_bf16 v[80:83], v[24:27], a[20:23], v[80:83]
v_max3_f32 v44, v36, v37, v38
v_max_f32 v44, v44, v39
v_sub_f32 v36, v36, v44
v_sub_f32 v37, v37, v44
v_sub_f32 v38, v38, v44
v_sub_f32 v39, v39, v44
s_waitcnt lgkmcnt(1)
v_mfma_f32_16x16x32_bf16 v[76:79], v[28:31], a[8:11], v[76:79]
v_mfma_f32_16x16x32_bf16 v[80:83], v[28:31], a[24:27], v[80:83]
v_exp_f32 v36, v36
v_exp_f32 v37, v37
v_exp_f32 v38, v38
v_exp_f32 v39, v39
s_waitcnt lgkmcnt(0)
v_mfma_f32_16x16x32_bf16 v[76:79], v[32:35], a[12:15], v[76:79]
v_mfma_f32_16x16x32_bf16 v[80:83], v[32:35], a[28:31], v[80:83]
v_mul_f32 v44, v36, v40
v_fma_f32 v44, v37, v41, v44
v_fma_f32 v44, v38, v42, v44
v_fma_f32 v44, v39, v43, v44
v_rcp_f32 v11, v44
s_nop 1
v_pk_mul_f32 v[76:77], v[76:77], v[36:37]
v_pk_mul_f32 v[80:81], v[80:81], v[36:37]
v_pk_fma_f32 v[76:77], v[78:79], v[38:39], v[76:77]
v_pk_fma_f32 v[80:81], v[82:83], v[38:39], v[80:81]
v_add_f32 v76, v76, v77
v_add_f32 v80, v80, v81
v_mul_f32 v76, v76, v11
v_mul_f32 v80, v80, v11
v_cvt_pk_bf16_f32 v76, v76, v80
s_nop 1
v_mov_b32_dpp v77, v76 quad_perm:[1,1,1,1] row_mask:0xf bank_mask:0xf
v_mov_b32_dpp v78, v76 quad_perm:[2,2,2,2] row_mask:0xf bank_mask:0xf
v_mov_b32_dpp v79, v76 quad_perm:[3,3,3,3] row_mask:0xf bank_mask:0xf
s_mov_b64 exec, 0x1111
buffer_store_dwordx4 v[76:79], v13, s[32:35], s53 offen
buffer_store_dwordx4 v[76:79], v13, s[32:35], s55 offen sc1
s_mov_b64 exec, -1
s_cmp_ge_u32 s3, 108
s_cbranch_scc1 L_end
s_barrier
s_mul_i32 s49, s59, 5120
s_mul_i32 s50, s31, 5120
s_add_u32 m0, s50, 73728
s_nop 0
buffer_load_dwordx4 v17, s[44:47], s49 offen offset:0  lds
buffer_load_dwordx4 v17, s[44:47], s49 offen offset:1024  lds
buffer_load_dwordx4 v17, s[44:47], s49 offen offset:2048  lds
buffer_load_dwordx4 v17, s[44:47], s49 offen offset:3072  lds
s_add_u32 s49, s49, 4096
s_add_u32 m0, m0, 4096
s_nop 0
buffer_load_dwordx4 v17, s[44:47], s49 offen  lds
v_and_b32 v8, 7, v1
v_mul_u32_u24 v8, 1280, v8
v_add_u32 v8, v8, v14
v_mov_b32 v18, 2147483632
v_cmp_gt_u32 vcc, 8, v1
s_nop 1
v_cndmask_b32 v18, v18, v8, vcc
v_lshrrev_b32 v9, 3, v1
v_lshl_add_u32 v8, v9, 6, v8
v_lshrrev_b32 v10, 1, v2
v_cmp_eq_u32 s[16:17], v9, v10
s_and_b32 s51, s31, 1
s_lshl_b32 s52, s51, 6
s_add_u32 s52, s52, s61
s_add_u32 s52, s52, 606208
s_lshl_b32 s51, s51, 8
s_sub_u32 s51, s61, s51
s_add_u32 s51, s51, 606464
s_lshr_b32 s26, s3, 4
s_mul_i32 s26, s26, 10240
s_add_u32 s52, s52, s26
s_add_u32 s51, s51, s26
s_mov_b32 s26, 0
s_mov_b32 s27, -1
s_lshl_b32 s53, s31, 2
s_add_u32 s53, s53, 100352
v_add_u32 v10, s53, v17
v_add_u32 v9, s53, v14
v_lshl_add_u32 v11, v2, 2, v19
v_lshlrev_b32 v11, 4, v11
v_add_u32 v11, 100352, v11
v_mov_b32 v12, 100352
v_and_b32 v13, 1, v1
v_lshl_add_u32 v15, v13, 6, v14
v_sub_u32 v16, 0, v13
v_not_b32 v13, v16
s_mul_i32 s53, s59, 640
s_add_u32 s53, s53, 327680
s_mov_b32 s54, 0x3d372713
s_waitcnt lgkmcnt(0)
v_mfma_f32_16x16x32_bf16 v[24:27], v[100:103], a[32:35], 0
v_mfma_f32_16x16x32_bf16 v[28:31], v[100:103], a[52:55], 0
v_mfma_f32_16x16x32_bf16 v[24:27], v[100:103], a[36:39], v[24:27]
v_mfma_f32_16x16x32_bf16 v[28:31], v[100:103], a[56:59], v[28:31]
v_mfma_f32_16x16x32_bf16 v[24:27], v[100:103], a[40:43], v[24:27]
v_mfma_f32_16x16x32_bf16 v[28:31], v[100:103], a[60:63], v[28:31]
v_mfma_f32_16x16x32_bf16 v[24:27], v[100:103], a[44:47], v[24:27]
v_mfma_f32_16x16x32_bf16 v[28:31], v[100:103], a[64:67], v[28:31]
v_mfma_f32_16x16x32_bf16 v[24:27], v[100:103], a[48:51], v[24:27]
v_mfma_f32_16x16x32_bf16 v[28:31], v[100:103], a[68:71], v[28:31]
s_nop 7
v_cndmask_b32 v24, v24, v28, s[26:27]
ds_write_b32 v10, v24 offset:4096
s_waitcnt vmcnt(0) lgkmcnt(0)
s_barrier
ds_read_b128 v[24:27], v11 offset:4096
ds_read_b128 v[28:31], v11 offset:4608
ds_read_b64_tr_b16 a[72:73], v106 offset:0
ds_read_b64_tr_b16 a[74:75], v106 offset:32
ds_read_b64_tr_b16 a[76:77], v106 offset:64
ds_read_b64_tr_b16 a[78:79], v106 offset:96
ds_read_b64_tr_b16 a[80:81], v106 offset:128
ds_read_b64_tr_b16 a[82:83], v106 offset:160
ds_read_b64_tr_b16 a[84:85], v106 offset:192
ds_read_b64_tr_b16 a[86:87], v106 offset:224
ds_read_b64_tr_b16 a[88:89], v106 offset:256
ds_read_b64_tr_b16 a[90:91], v106 offset:288
s_waitcnt lgkmcnt(0)
v_pk_add_f32 v[24:25], v[24:25], v[26:27]
v_pk_add_f32 v[28:29], v[28:29], v[30:31]
v_add_f32 v128, v24, v25
v_add_f32 v129, v28, v29
L_h4:
buffer_load_dwordx4 v[84:87], v8, s[32:35], s52 offen sc1
buffer_load_dwordx4 v[88:91], v8, s[32:35], s52 offen offset:128 sc1
buffer_load_dwordx4 v[92:95], v18, s[32:35], s51 offen sc1
s_sub_u32 s60, s60, 1
s_cbranch_scc1 L_end
L_h4c:
s_waitcnt vmcnt(0)
v_max3_u32 v3, v87, v91, v95
v_cmp_eq_u32 vcc, -1, v3
s_and_b64 exec, exec, vcc
s_cbranch_scc1 L_h4
s_mov_b64 exec, -1
v_mfma_f32_16x16x32_bf16 v[20:23], v[84:87], v[84:87], 0
v_mfma_f32_16x16x32_bf16 v[24:27], v[84:87], v[100:103], 0
v_mfma_f32_16x16x32_bf16 v[20:23], v[88:91], v[88:91], v[20:23]
v_mfma_f32_16x16x32_bf16 v[24:27], v[88:91], v[100:103], v[24:27]
v_mfma_f32_16x16x32_bf16 v[20:23], v[92:95], v[92:95], v[20:23]
v_mfma_f32_16x16x32_bf16 v[24:27], v[92:95], v[100:103], v[24:27]
v_mfma_f32_16x16x32_bf16 v[32:35], v[84:87], a[36:39], 0
v_mfma_f32_16x16x32_bf16 v[40:43], v[84:87], a[56:59], 0
s_nop 4
v_pk_add_f32 v[20:21], v[20:21], v[22:23]
v_pk_add_f32 v[24:25], v[24:25], v[26:27]
v_mfma_f32_16x16x32_bf16 v[32:35], v[88:91], a[44:47], v[32:35]
v_add_f32 v20, v20, v21
v_add_f32 v24, v24, v25
v_mfma_f32_16x16x32_bf16 v[40:43], v[88:91], a[64:67], v[40:43]
v_cndmask_b32 v20, 0, v20, s[16:17]
v_mfma_f32_16x16x32_bf16 v[28:31], v[84:87], a[32:35], 0
s_nop 0
v_add_f32_dpp v20, v20, v20 row_ror:8 row_mask:0xf bank_mask:0xf
v_mfma_f32_16x16x32_bf16 v[36:39], v[84:87], a[52:55], 0
s_nop 0
v_add_f32_dpp v20, v20, v20 row_ror:4 row_mask:0xf bank_mask:0xf
v_mfma_f32_16x16x32_bf16 v[28:31], v[88:91], a[40:43], v[28:31]
s_nop 0
v_add_f32_dpp v20, v20, v20 row_ror:2 row_mask:0xf bank_mask:0xf
v_mfma_f32_16x16x32_bf16 v[36:39], v[88:91], a[60:63], v[36:39]
s_nop 0
v_add_f32_dpp v20, v20, v20 row_ror:1 row_mask:0xf bank_mask:0xf
v_mfma_f32_16x16x32_bf16 v[28:31], v[92:95], a[48:51], v[28:31]
s_nop 0
v_permlane32_swap_b32 v20, v24
v_mfma_f32_16x16x32_bf16 v[36:39], v[92:95], a[68:71], v[36:39]
v_add_f32 v20, v20, v24
ds_write_b32 v9, v20 offset:1024
v_pk_add_f32 v[32:33], v[32:33], v[34:35]
v_pk_add_f32 v[40:41], v[40:41], v[42:43]
v_add_f32 v32, v32, v33
v_add_f32 v40, v40, v41
v_pk_add_f32 v[28:29], v[28:29], v[30:31]
v_add_f32 v28, v28, v29
v_pk_add_f32 v[36:37], v[36:37], v[38:39]
v_add_f32 v36, v36, v37
v_cndmask_b32 v28, v28, v32, s[26:27]
v_cndmask_b32 v36, v36, v40, s[26:27]
s_nop 1
v_permlane32_swap_b32 v28, v36
v_add_f32 v28, v28, v36
ds_write_b32 v10, v28
s_mov_b32 exec_lo, 0x000f000f
s_mov_b32 exec_hi, 0x000f000f
s_waitcnt lgkmcnt(0)
s_barrier
ds_read_b128 v[32:35], v12 offset:1056
ds_read_b128 v[36:39], v12 offset:1072
ds_read_b128 v[40:43], v12 offset:1024
ds_read_b128 v[60:63], v12 offset:1040
ds_read_b128 v[44:47], v11
ds_read_b128 v[48:51], v11 offset:256
ds_read_b128 v[52:55], v11 offset:512
ds_read_b128 v[56:59], v11 offset:768
s_waitcnt lgkmcnt(6)
v_pk_add_f32 v[32:33], v[32:33], v[34:35]
v_pk_add_f32 v[36:37], v[36:37], v[38:39]
v_pk_add_f32 v[32:33], v[32:33], v[36:37]
v_add_f32 v21, v32, v33
s_waitcnt lgkmcnt(4)
v_pk_add_f32 v[40:41], v[40:41], v[42:43]
v_pk_add_f32 v[60:61], v[60:61], v[62:63]
v_pk_add_f32 v[40:41], v[40:41], v[60:61]
v_add_f32 v20, v40, v41
v_mul_f32 v21, 0x3acccccd, v21
v_mul_f32 v20, 0x3acccccd, v20
v_fma_f32 v20, -v21, v21, v20
v_max_f32 v20, 0, v20
v_add_f32 v20, 0x3727c5ac, v20
v_rsq_f32 v20, v20
s_waitcnt lgkmcnt(2)
v_pk_add_f32 v[44:45], v[44:45], v[46:47]
v_pk_add_f32 v[48:49], v[48:49], v[50:51]
v_pk_add_f32 v[44:45], v[44:45], v[48:49]
v_add_f32 v24, v44, v45
s_waitcnt lgkmcnt(0)
v_pk_add_f32 v[52:53], v[52:53], v[54:55]
v_pk_add_f32 v[56:57], v[56:57], v[58:59]
v_fma_f32 v24, -v21, v128, v24
v_pk_add_f32 v[52:53], v[52:53], v[56:57]
v_add_f32 v25, v52, v53
v_fma_f32 v25, -v21, v129, v25
v_mul_f32 v24, v24, v20
v_mul_f32 v25, v25, v20
v_mul_f32 v26, v24, v24
v_mul_f32 v27, 0xc0135761, v24
v_fma_f32 v26, v26, s54, 1.0
v_mul_f32 v26, v26, v27
v_exp_f32 v26, v26
v_mul_f32 v25, v25, v24
v_add_f32 v26, 1.0, v26
v_rcp_f32 v26, v26
s_nop 0
v_mul_f32 v25, v25, v26
s_nop 1
v_mov_b32_dpp v26, v25 quad_perm:[1,1,3,3] row_mask:0xf bank_mask:0xf
v_cvt_pk_bf16_f32 v25, v25, v26
s_nop 1
v_and_b32_dpp v20, v25, v13 quad_perm:[0,0,0,0] row_mask:0xf bank_mask:0xf
v_and_b32_dpp v21, v25, v13 quad_perm:[2,2,2,2] row_mask:0xf bank_mask:0xf
v_and_b32_dpp v22, v25, v16 quad_perm:[0,0,0,0] row_mask:0xf bank_mask:0xf
v_and_b32_dpp v23, v25, v16 quad_perm:[2,2,2,2] row_mask:0xf bank_mask:0xf
s_mov_b64 exec, -1
s_nop 0
v_mfma_f32_16x16x32_bf16 v[32:35], a[72:75], v[20:23], 0
v_mfma_f32_16x16x32_bf16 v[36:39], a[76:79], v[20:23], 0
v_mfma_f32_16x16x32_bf16 v[40:43], a[80:83], v[20:23], 0
v_mfma_f32_16x16x32_bf16 v[44:47], a[84:87], v[20:23], 0
v_mfma_f32_16x16x32_bf16 v[48:51], a[88:91], v[20:23], 0
s_mov_b32 exec_lo, 0x00030003
s_mov_b32 exec_hi, 0x00030003
s_nop 1
buffer_store_dwordx4 v[32:35], v15, s[32:35], s53 offen offset:0 sc1
buffer_store_dwordx4 v[36:39], v15, s[32:35], s53 offen offset:128 sc1
buffer_store_dwordx4 v[40:43], v15, s[32:35], s53 offen offset:256 sc1
buffer_store_dwordx4 v[44:47], v15, s[32:35], s53 offen offset:384 sc1
buffer_store_dwordx4 v[48:51], v15, s[32:35], s53 offen offset:512 sc1
L_end:
s_waitcnt vmcnt(0)
L_exit:
s_endpgm
.section .rodata,"a"
.p2align 6
.amdhsa_kernel sequential_preLN__compressed_kv_cla__glu_gated_geglu__decode_kernel
  .amdhsa_next_free_vgpr 512
  .amdhsa_next_free_sgpr 102
  .amdhsa_accum_offset 256
  .amdhsa_group_segment_fixed_size 0
  .amdhsa_kernarg_size 104
  .amdhsa_user_sgpr_count 2
  .amdhsa_user_sgpr_kernarg_segment_ptr 1
  .amdhsa_system_sgpr_workgroup_id_x 1
.end_amdhsa_kernel
```
